```python
import torch

def _softmax(x, axis=-1):
    return torch.softmax(x, dim=axis)
def _gelu(x):
    return torch.nn.functional.gelu(x, approximate="tanh")
def _silu(x):
    return torch.nn.functional.silu(x)
def _sigmoid(x):
    return torch.sigmoid(x)
def _layernorm(x, axis=-1, eps=1e-5):
    m = x.mean(dim=axis, keepdim=True)
    v = x.var(dim=axis, keepdim=True, unbiased=False)
    return (x - m) / torch.sqrt(v + eps)
def _scatter_add(tgt, idx, src, axis=0):
    return tgt.clone().index_add_(axis, idx, src)
def _segment_sum(src, seg, n):
    out = torch.zeros((n,) + src.shape[1:], dtype=src.dtype)
    return out.index_add_(0, seg, src)
def _pad(x, pw):
    flat = tuple(v for pair in reversed(pw) for v in pair)
    return torch.nn.functional.pad(x, flat)

kernel_name = 'parallel_sum__spectral_fnet__dense_activation_relu__prompt'

def setup_inputs():

    _w = (lambda a: (lambda t: t.to(torch.bfloat16) if t.is_floating_point() else t)(torch.as_tensor(a)))
    def _A_setup():
        B, S, D = 1, 2048, 448
        ns = torch.arange(S)[:, None] * torch.arange(S)[None, :]
        nd = torch.arange(D)[:, None] * torch.arange(D)[None, :]
        Ws_re = torch.cos(-2.0 * torch.pi * ns / S).to(float)
        Ws_im = torch.sin(-2.0 * torch.pi * ns / S).to(float)
        Wd_re = torch.cos(-2.0 * torch.pi * nd / D).to(float)
        Wd_im = torch.sin(-2.0 * torch.pi * nd / D).to(float)
        return {
            "x": _w((lambda *s: torch.randn(*s, dtype=torch.bfloat16) * 0.05)(B, S, D)),
            "dft_seq_re": _w(Ws_re),
            "dft_seq_im": _w(Ws_im),
            "dft_hid_re": _w(Wd_re),
            "dft_hid_im": _w(Wd_im),
        }
    _A_in = _A_setup()

    def _B_setup():
        B, S, D, Dff = 1, 2048, 448, 1792
        return {
            "x": _w((lambda *s: torch.randn(*s, dtype=torch.bfloat16) * 0.05)(B, S, D)),
            "w1": _w((lambda *s: torch.randn(*s, dtype=torch.bfloat16) * 0.4)(D, Dff)),
            "w2": _w((lambda *s: torch.randn(*s, dtype=torch.bfloat16) * 0.4)(Dff, D)),
        }
    _B_in = _B_setup()

    return {
        "A_x": _A_in["x"],
        "A_dft_seq_re": _A_in["dft_seq_re"],
        "A_dft_seq_im": _A_in["dft_seq_im"],
        "A_dft_hid_re": _A_in["dft_hid_re"],
        "A_dft_hid_im": _A_in["dft_hid_im"],
        "B_x": _B_in["x"],
        "B_w1": _B_in["w1"],
        "B_w2": _B_in["w2"],
    }

def reference(A_x, A_dft_seq_re, A_dft_seq_im, A_dft_hid_re, A_dft_hid_im, B_x, B_w1, B_w2):
    def _A_ref(x, dft_seq_re, dft_seq_im, dft_hid_re, dft_hid_im):
        a = torch.einsum("bsd,ed->bse", x, dft_hid_re)
        b = torch.einsum("bsd,ed->bse", x, dft_hid_im)
        y = torch.einsum("ts,bse->bte", dft_seq_re, a) - torch.einsum("ts,bse->bte", dft_seq_im, b)
        return y

    def _B_ref(x, w1, w2):
        h = torch.einsum("bsd,df->bsf", x, w1)
        zero = torch.zeros_like(h)
        h = torch.maximum(h, zero)
        return torch.einsum("bsf,fd->bsd", h, w2)

    x = A_x
    xn = _layernorm(x, axis=-1)
    return x + _A_ref(xn, A_dft_seq_re, A_dft_seq_im, A_dft_hid_re, A_dft_hid_im) + _B_ref(xn, B_w1, B_w2)
```

```asm
; @launch grid=(256,1,1) block=(256,1,1) lds=163840
.amdgcn_target "amdgcn-amd-amdhsa--gfx950"
.text
.globl parallel_sum__spectral_fnet__dense_activation_relu__prompt_kernel
.p2align 8
.type parallel_sum__spectral_fnet__dense_activation_relu__prompt_kernel,@function
parallel_sum__spectral_fnet__dense_activation_relu__prompt_kernel:
    s_cmp_ge_u32 s2, 256
    s_cbranch_scc1 Lend
    s_load_dwordx2 s[4:5], s[0:1], 0
    s_load_dwordx4 s[8:11], s[0:1], 24
    s_load_dwordx4 s[12:15], s[0:1], 48
    s_load_dwordx2 s[16:17], s[0:1], 64
    s_load_dwordx2 s[18:19], s[0:1], 80
    s_getpc_b64 s[22:23]
Lpc:
    s_bfe_u32 s3, s2, 0x30003
    s_lshl_b32 s3, s3, 12
    v_lshrrev_b32 v46, 6, v0
    v_lshlrev_b32 v46, 10, v46
    v_and_b32 v47, 7, v0
    v_lshl_add_u32 v46, v47, 7, v46
    v_add_u32 v46, s3, v46
    v_min_u32 v46, Lend-Lpc, v46
    global_load_dword v47, v46, s[22:23]
    v_lshrrev_b32 v104, 6, v0
    v_and_b32 v1, 63, v0
    v_readfirstlane_b32 s58, v104
    s_and_b32 s75, s2, 7
    s_lshr_b32 s76, s2, 3
    s_and_b32 s67, s75, 3
    s_lshr_b32 s68, s75, 2
    s_lshr_b32 s59, s58, 1
    s_and_b32 s60, s58, 1
    s_cmp_ge_u32 s76, 28
    s_cbranch_scc1 LroleBC
    s_lshl_b32 s61, s67, 2
    s_and_b32 s69, s76, 3
    s_add_u32 s61, s61, s69
    s_lshr_b32 s71, s76, 2
    s_mul_i32 s62, s68, 7
    s_add_u32 s62, s62, s71
    s_lshl_b32 s81, s69, 1
    s_add_u32 s81, s81, s71
    s_sub_u32 s79, s81, 7
    s_cselect_b32 s81, s81, s79
    s_lshl_b32 s70, s75, 1
    s_lshr_b32 s79, s69, 1
    s_add_u32 s70, s70, s79
    s_sub_u32 s79, 32, s70
    s_cmp_eq_u32 s70, 0
    s_cselect_b32 s79, 16, s79
    s_bitcmp1_b32 s69, 0
    s_cselect_b32 s70, s79, s70
    s_add_u32 s80, s71, s69
    s_and_b32 s80, s80, 1
    s_mul_i32 s80, s80, 3
    s_mul_i32 s77, s75, 28
    s_add_u32 s77, s77, s76
    s_lshl_b32 s77, s77, 2
    s_add_u32 s77, s77, s58
    s_mul_i32 s74, s77, 1792
    s_lshl_b32 s63, s61, 1
    s_add_u32 s63, s63, s60
    s_lshl_b32 s67, s59, 5
    s_add_u32 s63, s63, s67
    v_lshrrev_b32 v105, 3, v1
    v_and_b32 v106, 7, v1
    v_lshrrev_b32 v107, 1, v105
    v_xor_b32 v108, v106, v107
    v_lshlrev_b32 v108, 4, v108
    v_mul_u32_u24 v109, 57344, v105
    s_mul_i32 s67, s63, 896
    v_add3_u32 v4, v109, v108, s67
    v_xor_b32 v5, 64, v4
    v_add_u32 v6, 915456, v4
    v_add_u32 v7, 1373184, v5
    v_add_u32 v5, 457728, v5
    v_and_b32 v110, 1, v107
    v_lshlrev_b32 v110, 2, v110
    v_xor_b32 v110, v110, v106
    v_lshlrev_b32 v110, 4, v110
    v_mul_u32_u24 v111, 3584, v105
    s_mul_i32 s67, s59, 114688
    s_lshl_b32 s68, s62, 8
    s_add_u32 s67, s67, s68
    s_lshl_b32 s68, s60, 7
    s_add_u32 s67, s67, s68
    v_add3_u32 v8, v111, v110, s67
    v_add_u32 v9, 27648, v8
    v_add_u32 v10, 55296, v8
    v_add_u32 v11, 82944, v8
    v_mul_u32_u24 v109, 896, v105
    s_lshl_b32 s67, s60, 6
    v_xor_b32 v110, s67, v108
    s_lshl_b32 s67, s62, 1
    s_add_u32 s67, s67, s60
    s_mul_i32 s67, s67, 7168
    v_add3_u32 v12, v109, v110, s67
    s_lshl_b32 s64, s58, 12
    s_lshl_b32 s65, s60, 13
    s_lshl_b32 s67, s59, 12
    s_add_u32 s65, s65, s67
    s_add_u32 s65, s65, 16384
    s_lshl_b32 s66, s58, 10
    s_add_u32 s66, s66, 32768
    s_waitcnt lgkmcnt(0)
    s_mov_b32 s24, s4
    s_mov_b32 s25, s5
    s_mov_b32 s26, 1835008
    s_mov_b32 s27, 0x20000
    s_cmp_ge_u32 s58, 2
    s_cselect_b32 s32, s10, s8
    s_cselect_b32 s33, s11, s9
    s_mov_b32 s34, 401408
    s_mov_b32 s35, 0x20000
    s_mov_b32 s28, s12
    s_mov_b32 s29, s13
    s_mov_b32 s30, 1605632
    s_mov_b32 s31, 0x20000
    s_mov_b32 s10, s80
    s_mov_b32 s6, s10
    s_lshl_b32 s72, s6, 7
    s_mul_i32 s73, s6, 229376
    s_add_u32 m0, s64, 0
    s_nop 0
    buffer_load_dwordx4 v4, s[24:27], s72 offen offset:0 lds
    buffer_load_dwordx4 v5, s[24:27], s72 offen offset:1024 lds
    buffer_load_dwordx4 v6, s[24:27], s72 offen offset:2048 lds
    buffer_load_dwordx4 v7, s[24:27], s72 offen offset:3072 lds
    s_add_u32 m0, s66, 0
    s_nop 0
    buffer_load_dwordx4 v12, s[32:35], s72 offen lds
    s_add_u32 m0, s65, 0
    s_nop 0
    buffer_load_dwordx4 v8, s[28:31], s73 offen offset:0 lds
    buffer_load_dwordx4 v9, s[28:31], s73 offen offset:1024 lds
    buffer_load_dwordx4 v10, s[28:31], s73 offen offset:2048 lds
    buffer_load_dwordx4 v11, s[28:31], s73 offen offset:3072 lds
    v_and_b32 v2, 31, v1
    v_lshrrev_b32 v3, 5, v1
    v_bfe_u32 v104, v2, 1, 3
    v_xor_b32 v104, v104, v3
    v_lshlrev_b32 v105, 7, v2
    s_xor_b32 s67, s58, 1
    s_lshl_b32 s67, s67, 12
    v_xor_b32 v106, 0, v104
    v_lshl_add_u32 v106, v106, 4, v105
    v_add_u32 v13, s64, v106
    v_add_u32 v21, s67, v106
    v_add_u32 v29, 0x8000, v106
    v_add_u32 v17, 73728, v13
    v_add_u32 v25, 73728, v21
    v_add_u32 v33, 73728, v29
    v_xor_b32 v106, 2, v104
    v_lshl_add_u32 v106, v106, 4, v105
    v_add_u32 v14, s64, v106
    v_add_u32 v22, s67, v106
    v_add_u32 v30, 0x8000, v106
    v_add_u32 v18, 73728, v14
    v_add_u32 v26, 73728, v22
    v_add_u32 v34, 73728, v30
    v_xor_b32 v106, 4, v104
    v_lshl_add_u32 v106, v106, 4, v105
    v_add_u32 v15, s64, v106
    v_add_u32 v23, s67, v106
    v_add_u32 v31, 0x8000, v106
    v_add_u32 v19, 73728, v15
    v_add_u32 v27, 73728, v23
    v_add_u32 v35, 73728, v31
    v_xor_b32 v106, 6, v104
    v_lshl_add_u32 v106, v106, 4, v105
    v_add_u32 v16, s64, v106
    v_add_u32 v24, s67, v106
    v_add_u32 v32, 0x8000, v106
    v_add_u32 v20, 73728, v16
    v_add_u32 v28, 73728, v24
    v_add_u32 v36, 73728, v32
    v_bfe_u32 v104, v1, 2, 2
    v_lshl_add_u32 v105, v3, 3, v104
    v_lshlrev_b32 v105, 7, v105
    v_lshrrev_b32 v104, 1, v104
    v_xor_b32 v104, s59, v104
    v_lshl_add_u32 v105, v104, 6, v105
    v_bfe_u32 v104, v1, 4, 1
    v_lshl_add_u32 v105, v104, 5, v105
    v_and_b32 v104, 3, v1
    v_lshl_add_u32 v105, v104, 3, v105
    s_lshl_b32 s67, s60, 13
    s_add_u32 s67, s67, 16384
    v_add_u32 v37, s67, v105
    v_xor_b32 v39, 64, v37
    v_add_u32 v38, 73728, v37
    v_add_u32 v40, 73728, v39
    s_add_u32 s6, s6, 1
    s_cmp_eq_u32 s6, 7
    s_cselect_b32 s6, 0, s6
    s_lshl_b32 s72, s6, 7
    s_mul_i32 s73, s6, 229376
    s_add_u32 m0, s64, 36864
    s_nop 0
    buffer_load_dwordx4 v4, s[24:27], s72 offen offset:0 lds
    buffer_load_dwordx4 v5, s[24:27], s72 offen offset:1024 lds
    buffer_load_dwordx4 v6, s[24:27], s72 offen offset:2048 lds
    buffer_load_dwordx4 v7, s[24:27], s72 offen offset:3072 lds
    s_add_u32 m0, s66, 36864
    s_nop 0
    buffer_load_dwordx4 v12, s[32:35], s72 offen lds
    s_add_u32 m0, s65, 36864
    s_nop 0
    buffer_load_dwordx4 v8, s[28:31], s73 offen offset:0 lds
    buffer_load_dwordx4 v9, s[28:31], s73 offen offset:1024 lds
    buffer_load_dwordx4 v10, s[28:31], s73 offen offset:2048 lds
    buffer_load_dwordx4 v11, s[28:31], s73 offen offset:3072 lds
    s_mov_b32 s48, s14
    s_mov_b32 s49, s15
    s_mov_b32 s50, 1605632
    s_mov_b32 s51, 0x20000
    v_and_b32 v48, 15, v1
    v_lshlrev_b32 v48, 7, v48
    buffer_load_dword v47, v48, s[48:51], s74 offen
    s_add_u32 s44, s18, 10485760
    s_addc_u32 s45, s19, 0
    s_mov_b32 s46, 131072
    s_mov_b32 s47, 0x20000
    s_load_dwordx2 s[56:57], s[44:45], 81920
    s_mov_b32 s36, s18
    s_mov_b32 s37, s19
    s_mov_b32 s38, 7602176
    s_mov_b32 s39, 0x20000
    s_add_u32 s40, s18, 8388608
    s_addc_u32 s41, s19, 0
    s_mov_b32 s42, 2097152
    s_mov_b32 s43, 0x20000
    s_mov_b32 s52, s16
    s_mov_b32 s53, s17
    s_mov_b32 s54, 1835008
    s_mov_b32 s55, 0x20000
    s_waitcnt lgkmcnt(0)
    s_add_u32 s56, s56, 0x7f4a7c15
    s_addc_u32 s57, s57, 0x9e3779b9
    s_waitcnt vmcnt(10)
    s_barrier
    ds_read_b64_tr_b16 v[112:113], v37 offset:0
    ds_read_b64_tr_b16 v[114:115], v37 offset:512
    ds_read_b128 v[104:107], v13 offset:0
    ds_read_b128 v[108:111], v21 offset:0
    ds_read_b64_tr_b16 v[116:117], v39 offset:0
    ds_read_b64_tr_b16 v[118:119], v39 offset:512
    ds_read_b128 v[120:123], v29 offset:0
    s_waitcnt lgkmcnt(4)
    v_mfma_f32_32x32x16_bf16 v[144:159], v[112:115], v[104:107], 0
    ds_read_b64_tr_b16 v[132:133], v37 offset:2048
    ds_read_b64_tr_b16 v[134:135], v37 offset:2560
    ds_read_b128 v[124:127], v14 offset:0
    v_lshlrev_b32 v42, 4, v2
    v_add_u32 v41, -1, v3
    s_waitcnt lgkmcnt(6)
    v_mfma_f32_32x32x16_bf16 v[160:175], v[112:115], v[108:111], 0
    ds_read_b128 v[128:131], v22 offset:0
    ds_read_b64_tr_b16 v[136:137], v39 offset:2048
    ds_read_b64_tr_b16 v[138:139], v39 offset:2560
    s_lshl_b32 s79, s58, 7
    s_add_u32 s79, s79, 155648
    s_waitcnt lgkmcnt(7)
    v_mfma_f32_32x32x16_bf16 v[192:207], v[116:119], v[108:111], 0
    ds_read_b128 v[140:143], v30 offset:0
    s_add_u32 s6, s6, 1
    s_cmp_eq_u32 s6, 7
    s_cselect_b32 s6, 0, s6
    s_lshl_b32 s72, s6, 7
    s_mul_i32 s73, s6, 229376
    s_add_u32 m0, s64, 73728
    s_nop 0
    buffer_load_dwordx4 v4, s[24:27], s72 offen offset:0 lds
    v_mfma_f32_32x32x16_bf16 v[176:191], v[116:119], v[104:107], 0
    buffer_load_dwordx4 v5, s[24:27], s72 offen offset:1024 lds
    v_lshl_add_u32 v44, v2, 2, s79
    v_lshl_add_u32 v43, v3, 4, s79
    v_bfe_u32 v84, v1, 4, 1
    v_xor_b32 v78, 1, v84
    s_waitcnt lgkmcnt(7)
    v_mfma_f32_32x32x16_bf16 v[208:223], v[104:107], v[120:123], 0
    buffer_load_dwordx4 v6, s[24:27], s72 offen offset:2048 lds
    v_mul_u32_u24 v78, 0x8000, v78
    v_lshl_or_b32 v78, v78, 16, v78
    v_lshl_add_u32 v84, v3, 2, v84
    v_lshlrev_b32 v84, 8, v84
    s_waitcnt lgkmcnt(4)
    v_mfma_f32_32x32x16_bf16 v[144:159], v[132:135], v[124:127], v[144:159]
    ds_read_b64_tr_b16 v[112:113], v37 offset:4096
    ds_read_b64_tr_b16 v[114:115], v37 offset:4608
    ds_read_b128 v[104:107], v15 offset:0
    v_and_b32 v85, 15, v1
    v_lshl_add_u32 v84, v85, 4, v84
    s_waitcnt lgkmcnt(6)
    v_mfma_f32_32x32x16_bf16 v[160:175], v[132:135], v[128:131], v[160:175]
    ds_read_b128 v[108:111], v23 offset:0
    ds_read_b64_tr_b16 v[116:117], v39 offset:4096
    ds_read_b64_tr_b16 v[118:119], v39 offset:4608
    s_lshl_b32 s79, s58, 2
    s_add_u32 s79, s79, 147456
    s_waitcnt lgkmcnt(7)
    v_mfma_f32_32x32x16_bf16 v[192:207], v[136:139], v[128:131], v[192:207]
    ds_read_b128 v[120:123], v31 offset:0
    buffer_load_dwordx4 v7, s[24:27], s72 offen offset:3072 lds
    v_add_u32 v79, s79, v84
    s_lshl_b32 s79, s58, 11
    s_add_u32 s79, s79, 147456
    v_mfma_f32_32x32x16_bf16 v[176:191], v[136:139], v[124:127], v[176:191]
    s_add_u32 m0, s66, 73728
    s_nop 0
    buffer_load_dwordx4 v12, s[32:35], s72 offen lds
    v_lshlrev_b32 v82, 4, v1
    v_add_u32 v80, s79, v82
    s_waitcnt lgkmcnt(7)
    v_mfma_f32_32x32x16_bf16 v[208:223], v[124:127], v[140:143], v[208:223]
    s_add_u32 m0, s65, 73728
    s_nop 0
    buffer_load_dwordx4 v8, s[28:31], s73 offen offset:0 lds
    v_lshrrev_b32 v84, 4, v1
    v_lshlrev_b32 v84, 16, v84
    s_waitcnt lgkmcnt(4)
    v_mfma_f32_32x32x16_bf16 v[144:159], v[112:115], v[104:107], v[144:159]
    ds_read_b64_tr_b16 v[132:133], v37 offset:6144
    ds_read_b64_tr_b16 v[134:135], v37 offset:6656
    ds_read_b128 v[124:127], v16 offset:0
    v_lshl_add_u32 v84, v85, 4, v84
    s_waitcnt lgkmcnt(6)
    v_mfma_f32_32x32x16_bf16 v[160:175], v[112:115], v[108:111], v[160:175]
    ds_read_b128 v[128:131], v24 offset:0
    ds_read_b64_tr_b16 v[136:137], v39 offset:6144
    ds_read_b64_tr_b16 v[138:139], v39 offset:6656
    s_waitcnt lgkmcnt(7)
    v_mfma_f32_32x32x16_bf16 v[192:207], v[116:119], v[108:111], v[192:207]
    ds_read_b128 v[140:143], v32 offset:0
    buffer_load_dwordx4 v9, s[28:31], s73 offen offset:1024 lds
    s_lshl_b32 s79, s58, 19
    s_lshl_b32 s80, s61, 12
    s_add_u32 s79, s79, s80
    s_lshl_b32 s80, s62, 8
    s_add_u32 s79, s79, s80
    v_mfma_f32_32x32x16_bf16 v[176:191], v[116:119], v[104:107], v[176:191]
    buffer_load_dwordx4 v10, s[28:31], s73 offen offset:2048 lds
    v_add_u32 v81, s79, v84
    s_lshl_b32 s79, s62, 3
    s_lshl_b32 s80, s60, 2
    s_add_u32 s79, s79, s80
    s_lshl_b32 s80, s59, 1
    s_add_u32 s79, s79, s80
    s_waitcnt lgkmcnt(7)
    v_mfma_f32_32x32x16_bf16 v[208:223], v[104:107], v[120:123], v[208:223]
    buffer_load_dwordx4 v11, s[28:31], s73 offen offset:3072 lds
    s_lshl_b32 s79, s79, 10
    s_mul_i32 s80, s63, 118784
    s_add_u32 s4, s79, s80
    s_waitcnt lgkmcnt(4)
    v_mfma_f32_32x32x16_bf16 v[144:159], v[132:135], v[124:127], v[144:159]
    s_xor_b32 s80, s63, 1
    s_mul_i32 s80, s80, 118784
    s_add_u32 s5, s79, s80
    s_xor_b32 s8, s4, 2048
    s_xor_b32 s9, s5, 2048
    s_waitcnt lgkmcnt(3)
    v_mfma_f32_32x32x16_bf16 v[160:175], v[132:135], v[128:131], v[160:175]
    s_waitcnt lgkmcnt(0)
    s_waitcnt vmcnt(10)
    s_barrier
    ds_read_b64_tr_b16 v[112:113], v37 offset:36864
    ds_read_b64_tr_b16 v[114:115], v37 offset:37376
    ds_read_b128 v[104:107], v13 offset:36864
    ds_read_b128 v[108:111], v21 offset:36864
    v_mfma_f32_32x32x16_bf16 v[192:207], v[136:139], v[128:131], v[192:207]
    ds_read_b64_tr_b16 v[116:117], v39 offset:36864
    ds_read_b64_tr_b16 v[118:119], v39 offset:37376
    ds_read_b128 v[120:123], v29 offset:36864
    s_add_u32 s6, s6, 1
    s_cmp_eq_u32 s6, 7
    s_cselect_b32 s6, 0, s6
    s_lshl_b32 s72, s6, 7
    s_mul_i32 s73, s6, 229376
    s_add_u32 m0, s64, 110592
    s_nop 0
    buffer_load_dwordx4 v4, s[24:27], s72 offen offset:0 lds
    v_mfma_f32_32x32x16_bf16 v[176:191], v[136:139], v[124:127], v[176:191]
    buffer_load_dwordx4 v5, s[24:27], s72 offen offset:1024 lds
    v_lshrrev_b32 v85, 3, v1
    v_and_b32 v86, 7, v1
    v_bfe_u32 v87, v1, 4, 1
    v_lshlrev_b32 v87, 2, v87
    v_mfma_f32_32x32x16_bf16 v[208:223], v[124:127], v[140:143], v[208:223]
    buffer_load_dwordx4 v6, s[24:27], s72 offen offset:2048 lds
    v_xor_b32 v87, v87, v86
    v_lshlrev_b32 v87, 4, v87
    v_mul_u32_u24 v88, 896, v85
    s_waitcnt lgkmcnt(4)
    v_mfma_f32_32x32x16_bf16 v[144:159], v[112:115], v[104:107], v[144:159]
    ds_read_b64_tr_b16 v[132:133], v37 offset:38912
    ds_read_b64_tr_b16 v[134:135], v37 offset:39424
    ds_read_b128 v[124:127], v14 offset:36864
    s_waitcnt lgkmcnt(6)
    v_mfma_f32_32x32x16_bf16 v[160:175], v[112:115], v[108:111], v[160:175]
    ds_read_b128 v[128:131], v22 offset:36864
    ds_read_b64_tr_b16 v[136:137], v39 offset:38912
    ds_read_b64_tr_b16 v[138:139], v39 offset:39424
    s_waitcnt lgkmcnt(7)
    v_mfma_f32_32x32x16_bf16 v[192:207], v[116:119], v[108:111], v[192:207]
    ds_read_b128 v[140:143], v30 offset:36864
    buffer_load_dwordx4 v7, s[24:27], s72 offen offset:3072 lds
    s_mul_i32 s79, s58, 401408
    s_lshl_b32 s80, s71, 7
    s_add_u32 s79, s79, s80
    v_mfma_f32_32x32x16_bf16 v[176:191], v[116:119], v[104:107], v[176:191]
    s_add_u32 m0, s66, 110592
    s_nop 0
    buffer_load_dwordx4 v12, s[32:35], s72 offen lds
    v_add3_u32 v48, v88, v87, s79
    v_add_u32 v49, 6144, v48
    s_waitcnt lgkmcnt(7)
    v_mfma_f32_32x32x16_bf16 v[208:223], v[104:107], v[120:123], v[208:223]
    s_add_u32 m0, s65, 110592
    s_nop 0
    buffer_load_dwordx4 v8, s[28:31], s73 offen offset:0 lds
    v_add_u32 v50, 12288, v48
    v_add_u32 v51, 18432, v48
    s_waitcnt lgkmcnt(4)
    v_mfma_f32_32x32x16_bf16 v[144:159], v[132:135], v[124:127], v[144:159]
    ds_read_b64_tr_b16 v[112:113], v37 offset:40960
    ds_read_b64_tr_b16 v[114:115], v37 offset:41472
    ds_read_b128 v[104:107], v15 offset:36864
    v_bfe_u32 v84, v1, 2, 2
    v_lshl_add_u32 v85, v3, 2, v84
    s_waitcnt lgkmcnt(6)
    v_mfma_f32_32x32x16_bf16 v[160:175], v[132:135], v[128:131], v[160:175]
    ds_read_b128 v[108:111], v23 offset:36864
    ds_read_b64_tr_b16 v[116:117], v39 offset:40960
    ds_read_b64_tr_b16 v[118:119], v39 offset:41472
    v_lshlrev_b32 v85, 7, v85
    v_lshrrev_b32 v84, 1, v84
    s_waitcnt lgkmcnt(7)
    v_mfma_f32_32x32x16_bf16 v[192:207], v[136:139], v[128:131], v[192:207]
    ds_read_b128 v[120:123], v31 offset:36864
    buffer_load_dwordx4 v9, s[28:31], s73 offen offset:1024 lds
    v_xor_b32 v84, s60, v84
    v_lshl_add_u32 v85, v84, 6, v85
    v_bfe_u32 v84, v1, 4, 1
    v_mfma_f32_32x32x16_bf16 v[176:191], v[136:139], v[124:127], v[176:191]
    buffer_load_dwordx4 v10, s[28:31], s73 offen offset:2048 lds
    v_lshl_add_u32 v85, v84, 5, v85
    v_and_b32 v84, 3, v1
    v_lshl_add_u32 v85, v84, 3, v85
    s_mul_i32 s20, s58, 40960
    s_waitcnt lgkmcnt(7)
    v_mfma_f32_32x32x16_bf16 v[208:223], v[124:127], v[140:143], v[208:223]
    buffer_load_dwordx4 v11, s[28:31], s73 offen offset:3072 lds
    v_add_u32 v52, s20, v85
    v_xor_b32 v53, 64, v52
    s_lshl_b32 s11, s58, 13
    v_add_u32 v77, s11, v85
    s_waitcnt lgkmcnt(4)
    v_mfma_f32_32x32x16_bf16 v[144:159], v[112:115], v[104:107], v[144:159]
    ds_read_b64_tr_b16 v[132:133], v37 offset:43008
    ds_read_b64_tr_b16 v[134:135], v37 offset:43520
    ds_read_b128 v[124:127], v16 offset:36864
    v_xor_b32 v83, 64, v77
    v_add_u32 v54, 110592, v77
    s_waitcnt lgkmcnt(6)
    v_mfma_f32_32x32x16_bf16 v[160:175], v[112:115], v[108:111], v[160:175]
    ds_read_b128 v[128:131], v24 offset:36864
    ds_read_b64_tr_b16 v[136:137], v39 offset:43008
    ds_read_b64_tr_b16 v[138:139], v39 offset:43520
    v_add_u32 v73, 110592, v83
    s_waitcnt lgkmcnt(7)
    v_mfma_f32_32x32x16_bf16 v[192:207], v[116:119], v[108:111], v[192:207]
    ds_read_b128 v[140:143], v32 offset:36864
    s_mov_b64 exec, 1
    buffer_load_dword v46, v82, s[36:39], s4 offen
    buffer_load_dword v46, v82, s[36:39], s5 offen
    s_mov_b32 exec_lo, 0x00010001
    s_mov_b32 exec_hi, 0x00010001
    buffer_load_dword v46, v81, s[40:43], 0 offen
    s_mov_b32 s67, 262144
    buffer_load_dword v46, v81, s[40:43], s67 offen
    s_mov_b64 exec, -1
    v_mfma_f32_32x32x16_bf16 v[176:191], v[116:119], v[104:107], v[176:191]
    s_add_u32 s6, s6, 1
    s_cmp_eq_u32 s6, 7
    s_cselect_b32 s6, 0, s6
    s_lshl_b32 s72, s6, 7
    s_mul_i32 s73, s6, 229376
    s_add_u32 m0, s64, 0
    s_nop 0
    buffer_load_dwordx4 v4, s[24:27], s72 offen offset:0 lds
    s_waitcnt lgkmcnt(7)
    v_mfma_f32_32x32x16_bf16 v[208:223], v[104:107], v[120:123], v[208:223]
    buffer_load_dwordx4 v5, s[24:27], s72 offen offset:1024 lds
    s_lshl_b32 s79, s71, 6
    s_lshl_b32 s80, s60, 5
    s_add_u32 s79, s79, s80
    v_add_u32 v84, s79, v2
    s_waitcnt lgkmcnt(4)
    v_mfma_f32_32x32x16_bf16 v[144:159], v[132:135], v[124:127], v[144:159]
    v_sub_u32 v90, 448, v84
    s_sub_u32 s79, 32, s70
    s_and_b32 s79, s79, 31
    v_mov_b32 v85, s70
    v_mov_b32 v91, s79
    s_waitcnt lgkmcnt(3)
    v_mfma_f32_32x32x16_bf16 v[160:175], v[132:135], v[128:131], v[160:175]
    s_waitcnt lgkmcnt(0)
    s_waitcnt vmcnt(15)
    s_barrier
    ds_read_b64_tr_b16 v[112:113], v38 offset:0
    ds_read_b64_tr_b16 v[114:115], v38 offset:512
    ds_read_b128 v[104:107], v17 offset:0
    ds_read_b128 v[108:111], v25 offset:0
    v_mfma_f32_32x32x16_bf16 v[192:207], v[136:139], v[128:131], v[192:207]
    ds_read_b64_tr_b16 v[116:117], v40 offset:0
    ds_read_b64_tr_b16 v[118:119], v40 offset:512
    ds_read_b128 v[120:123], v33 offset:0
    buffer_load_dwordx4 v6, s[24:27], s72 offen offset:2048 lds
    v_mfma_f32_32x32x16_bf16 v[176:191], v[136:139], v[124:127], v[176:191]
    buffer_load_dwordx4 v7, s[24:27], s72 offen offset:3072 lds
    v_cmp_lt_u32 vcc, 239, v84
    s_nop 1
    v_cndmask_b32 v84, v84, v90, vcc
    v_cndmask_b32 v85, v85, v91, vcc
    v_mov_b32 v90, 0
    v_bfrev_b32 v91, 1
    v_cndmask_b32 v72, v90, v91, vcc
    v_mfma_f32_32x32x16_bf16 v[208:223], v[124:127], v[140:143], v[208:223]
    s_add_u32 m0, s66, 0
    s_nop 0
    buffer_load_dwordx4 v12, s[32:35], s72 offen lds
    v_lshlrev_b32 v45, 16, v85
    v_lshl_add_u32 v45, v84, 4, v45
    s_waitcnt lgkmcnt(4)
    v_mfma_f32_32x32x16_bf16 v[144:159], v[112:115], v[104:107], v[144:159]
    ds_read_b64_tr_b16 v[132:133], v38 offset:2048
    ds_read_b64_tr_b16 v[134:135], v38 offset:2560
    ds_read_b128 v[124:127], v18 offset:0
    v_lshl_add_u32 v45, v3, 15, v45
    s_lshl_b32 s79, s59, 14
    s_waitcnt lgkmcnt(6)
    v_mfma_f32_32x32x16_bf16 v[160:175], v[112:115], v[108:111], v[160:175]
    ds_read_b128 v[128:131], v26 offset:0
    ds_read_b64_tr_b16 v[136:137], v40 offset:2048
    ds_read_b64_tr_b16 v[138:139], v40 offset:2560
    v_add_u32 v45, s79, v45
    v_and_b32 v86, 48, v1
    s_waitcnt lgkmcnt(7)
    v_mfma_f32_32x32x16_bf16 v[192:207], v[116:119], v[108:111], v[192:207]
    ds_read_b128 v[140:143], v34 offset:0
    s_add_u32 m0, s65, 0
    s_nop 0
    buffer_load_dwordx4 v8, s[28:31], s73 offen offset:0 lds
    v_subrev_u32 v86, 16, v86
    v_mfma_f32_32x32x16_bf16 v[176:191], v[116:119], v[104:107], v[176:191]
    buffer_load_dwordx4 v9, s[28:31], s73 offen offset:1024 lds
    v_min_u32 v86, 31, v86
    s_lshl_b32 s79, s71, 6
    s_lshl_b32 s80, s60, 5
    s_add_u32 s79, s79, s80
    s_waitcnt lgkmcnt(7)
    v_mfma_f32_32x32x16_bf16 v[208:223], v[104:107], v[120:123], v[208:223]
    buffer_load_dwordx4 v10, s[28:31], s73 offen offset:2048 lds
    v_add_u32 v84, s79, v86
    v_sub_u32 v90, 448, v84
    s_sub_u32 s79, 32, s70
    s_and_b32 s79, s79, 31
    s_waitcnt lgkmcnt(4)
    v_mfma_f32_32x32x16_bf16 v[144:159], v[132:135], v[124:127], v[144:159]
    ds_read_b64_tr_b16 v[112:113], v38 offset:4096
    ds_read_b64_tr_b16 v[114:115], v38 offset:4608
    ds_read_b128 v[104:107], v19 offset:0
    v_mov_b32 v85, s70
    v_mov_b32 v91, s79
    s_waitcnt lgkmcnt(6)
    v_mfma_f32_32x32x16_bf16 v[160:175], v[132:135], v[128:131], v[160:175]
    ds_read_b128 v[108:111], v27 offset:0
    ds_read_b64_tr_b16 v[116:117], v40 offset:4096
    ds_read_b64_tr_b16 v[118:119], v40 offset:4608
    s_waitcnt lgkmcnt(7)
    v_mfma_f32_32x32x16_bf16 v[192:207], v[136:139], v[128:131], v[192:207]
    ds_read_b128 v[120:123], v35 offset:0
    buffer_load_dwordx4 v11, s[28:31], s73 offen offset:3072 lds
    v_cmp_lt_u32 vcc, 239, v84
    s_nop 1
    v_cndmask_b32 v84, v84, v90, vcc
    v_cndmask_b32 v85, v85, v91, vcc
    v_mfma_f32_32x32x16_bf16 v[176:191], v[136:139], v[124:127], v[176:191]
    s_add_u32 s6, s6, 1
    s_cmp_eq_u32 s6, 7
    s_cselect_b32 s6, 0, s6
    s_lshl_b32 s72, s6, 7
    s_mul_i32 s73, s6, 229376
    s_add_u32 m0, s64, 36864
    s_nop 0
    buffer_load_dwordx4 v4, s[24:27], s72 offen offset:0 lds
    s_waitcnt lgkmcnt(7)
    v_mfma_f32_32x32x16_bf16 v[208:223], v[124:127], v[140:143], v[208:223]
    buffer_load_dwordx4 v5, s[24:27], s72 offen offset:1024 lds
    v_and_b32 v84, 0x1f0, v84
    v_and_b32 v86, 15, v1
    v_add_u32 v84, v84, v86
    v_lshlrev_b32 v84, 3, v84
    s_waitcnt lgkmcnt(4)
    v_mfma_f32_32x32x16_bf16 v[144:159], v[112:115], v[104:107], v[144:159]
    ds_read_b64_tr_b16 v[132:133], v38 offset:6144
    ds_read_b64_tr_b16 v[134:135], v38 offset:6656
    ds_read_b128 v[124:127], v20 offset:0
    v_add_u32 v55, 69632, v84
    s_waitcnt lgkmcnt(6)
    v_mfma_f32_32x32x16_bf16 v[160:175], v[112:115], v[108:111], v[160:175]
    ds_read_b128 v[128:131], v28 offset:0
    ds_read_b64_tr_b16 v[136:137], v40 offset:6144
    ds_read_b64_tr_b16 v[138:139], v40 offset:6656
    s_waitcnt lgkmcnt(7)
    v_mfma_f32_32x32x16_bf16 v[192:207], v[116:119], v[108:111], v[192:207]
    ds_read_b128 v[140:143], v36 offset:0
    buffer_load_dwordx4 v6, s[24:27], s72 offen offset:2048 lds
    s_mul_i32 s79, s58, 7
    s_lshr_b32 s79, s79, 1
    s_lshr_b32 s80, s70, 1
    s_lshl_b32 s80, s80, 4
    s_add_u32 s79, s79, s80
    v_mfma_f32_32x32x16_bf16 v[176:191], v[116:119], v[104:107], v[176:191]
    buffer_load_dwordx4 v7, s[24:27], s72 offen offset:3072 lds
    s_lshl_b32 s79, s79, 3
    s_add_u32 s79, s79, 65536
    v_and_b32 v84, 3, v1
    v_lshl_add_u32 v84, v84, 3, s79
    s_waitcnt lgkmcnt(7)
    v_mfma_f32_32x32x16_bf16 v[208:223], v[104:107], v[120:123], v[208:223]
    s_add_u32 m0, s66, 36864
    s_nop 0
    buffer_load_dwordx4 v12, s[32:35], s72 offen lds
    s_waitcnt lgkmcnt(4)
    v_mfma_f32_32x32x16_bf16 v[144:159], v[132:135], v[124:127], v[144:159]
    v_cmp_gt_u32 vcc, 16, v1
    s_nop 1
    v_cndmask_b32 v55, v55, v84, vcc
    v_lshrrev_b32 v84, 2, v1
    s_lshl_b32 s79, s59, 4
    s_waitcnt lgkmcnt(3)
    v_mfma_f32_32x32x16_bf16 v[160:175], v[132:135], v[128:131], v[160:175]
    s_waitcnt lgkmcnt(0)
    s_waitcnt vmcnt(18)
    s_barrier
    ds_read_b64_tr_b16 v[112:113], v38 offset:36864
    ds_read_b64_tr_b16 v[114:115], v38 offset:37376
    ds_read_b128 v[104:107], v17 offset:36864
    ds_read_b128 v[108:111], v25 offset:36864
    v_mfma_f32_32x32x16_bf16 v[192:207], v[136:139], v[128:131], v[192:207]
    ds_read_b64_tr_b16 v[116:117], v40 offset:36864
    ds_read_b64_tr_b16 v[118:119], v40 offset:37376
    ds_read_b128 v[120:123], v33 offset:36864
    s_add_u32 m0, s65, 36864
    s_nop 0
    buffer_load_dwordx4 v8, s[28:31], s73 offen offset:0 lds
    v_mfma_f32_32x32x16_bf16 v[176:191], v[136:139], v[124:127], v[176:191]
    buffer_load_dwordx4 v9, s[28:31], s73 offen offset:1024 lds
    v_add_u32 v84, s79, v84
    v_and_b32 v85, 3, v1
    v_mul_u32_u24 v86, 57344, v84
    v_lshl_add_u32 v86, v85, 4, v86
    v_mfma_f32_32x32x16_bf16 v[208:223], v[124:127], v[140:143], v[208:223]
    buffer_load_dwordx4 v10, s[28:31], s73 offen offset:2048 lds
    s_lshl_b32 s77, s59, 5
    s_add_u32 s77, s77, s70
    s_mul_i32 s79, s70, 896
    s_lshl_b32 s80, s71, 7
    s_waitcnt lgkmcnt(4)
    v_mfma_f32_32x32x16_bf16 v[144:159], v[112:115], v[104:107], v[144:159]
    ds_read_b64_tr_b16 v[132:133], v38 offset:38912
    ds_read_b64_tr_b16 v[134:135], v38 offset:39424
    ds_read_b128 v[124:127], v18 offset:36864
    s_waitcnt lgkmcnt(6)
    v_mfma_f32_32x32x16_bf16 v[160:175], v[112:115], v[108:111], v[160:175]
    ds_read_b128 v[128:131], v26 offset:36864
    ds_read_b64_tr_b16 v[136:137], v40 offset:38912
    ds_read_b64_tr_b16 v[138:139], v40 offset:39424
    s_waitcnt lgkmcnt(7)
    v_mfma_f32_32x32x16_bf16 v[192:207], v[116:119], v[108:111], v[192:207]
    ds_read_b128 v[140:143], v34 offset:36864
    buffer_load_dwordx4 v11, s[28:31], s73 offen offset:3072 lds
    s_add_u32 s79, s79, s80
    s_lshl_b32 s80, s60, 6
    s_add_u32 s79, s79, s80
    s_lshl_b32 s77, s77, 9
    v_mfma_f32_32x32x16_bf16 v[176:191], v[116:119], v[104:107], v[176:191]
    s_add_u32 s6, s6, 1
    s_cmp_eq_u32 s6, 7
    s_cselect_b32 s6, 0, s6
    s_lshl_b32 s72, s6, 7
    s_mul_i32 s73, s6, 229376
    s_add_u32 m0, s64, 73728
    s_nop 0
    buffer_load_dwordx4 v4, s[24:27], s72 offen offset:0 lds
    s_waitcnt lgkmcnt(7)
    v_mfma_f32_32x32x16_bf16 v[208:223], v[104:107], v[120:123], v[208:223]
    buffer_load_dwordx4 v5, s[24:27], s72 offen offset:1024 lds
    v_add_u32 v74, s79, v86
    v_add_u32 v75, 28672, v74
    v_lshlrev_b32 v76, 4, v84
    s_waitcnt lgkmcnt(4)
    v_mfma_f32_32x32x16_bf16 v[144:159], v[132:135], v[124:127], v[144:159]
    ds_read_b64_tr_b16 v[112:113], v38 offset:40960
    ds_read_b64_tr_b16 v[114:115], v38 offset:41472
    ds_read_b128 v[104:107], v19 offset:36864
    s_waitcnt lgkmcnt(6)
    v_mfma_f32_32x32x16_bf16 v[160:175], v[132:135], v[128:131], v[160:175]
    ds_read_b128 v[108:111], v27 offset:36864
    ds_read_b64_tr_b16 v[116:117], v40 offset:40960
    ds_read_b64_tr_b16 v[118:119], v40 offset:41472
    s_waitcnt lgkmcnt(7)
    v_mfma_f32_32x32x16_bf16 v[192:207], v[136:139], v[128:131], v[192:207]
    ds_read_b128 v[120:123], v35 offset:36864
    buffer_load_dwordx4 v6, s[24:27], s72 offen offset:2048 lds
    s_mul_i32 s21, s70, 118784
    s_mul_i32 s79, s58, 28672
    s_add_u32 s21, s21, s79
    v_mfma_f32_32x32x16_bf16 v[176:191], v[136:139], v[124:127], v[176:191]
    buffer_load_dwordx4 v7, s[24:27], s72 offen offset:3072 lds
    v_cvt_f32_u32 v84, v2
    v_cvt_f32_u32 v85, v3
    v_mul_f32 v84, 0x3d000000, v84
    v_mul_f32 v85, 4.0, v85
    s_waitcnt lgkmcnt(7)
    v_mfma_f32_32x32x16_bf16 v[208:223], v[124:127], v[140:143], v[208:223]
    s_add_u32 m0, s66, 73728
    s_nop 0
    buffer_load_dwordx4 v12, s[32:35], s72 offen lds
    v_mul_f32 v85, v85, v84
    v_fmamk_f32 v86, v84, 0x00000000, v85
    s_waitcnt lgkmcnt(4)
    v_mfma_f32_32x32x16_bf16 v[144:159], v[112:115], v[104:107], v[144:159]
    ds_read_b64_tr_b16 v[132:133], v38 offset:43008
    ds_read_b64_tr_b16 v[134:135], v38 offset:43520
    ds_read_b128 v[124:127], v20 offset:36864
    v_fmamk_f32 v87, v84, 0x3f800000, v85
    s_waitcnt lgkmcnt(6)
    v_mfma_f32_32x32x16_bf16 v[160:175], v[112:115], v[108:111], v[160:175]
    ds_read_b128 v[128:131], v28 offset:36864
    ds_read_b64_tr_b16 v[136:137], v40 offset:43008
    ds_read_b64_tr_b16 v[138:139], v40 offset:43520
    v_cos_f32 v88, v86
    s_waitcnt lgkmcnt(7)
    v_mfma_f32_32x32x16_bf16 v[192:207], v[116:119], v[108:111], v[192:207]
    ds_read_b128 v[140:143], v36 offset:36864
    s_add_u32 m0, s65, 73728
    s_nop 0
    buffer_load_dwordx4 v8, s[28:31], s73 offen offset:0 lds
    v_mfma_f32_32x32x16_bf16 v[176:191], v[116:119], v[104:107], v[176:191]
    buffer_load_dwordx4 v9, s[28:31], s73 offen offset:1024 lds
    v_cos_f32 v89, v87
    v_sin_f32 v90, v86
    s_waitcnt lgkmcnt(7)
    v_mfma_f32_32x32x16_bf16 v[208:223], v[104:107], v[120:123], v[208:223]
    buffer_load_dwordx4 v10, s[28:31], s73 offen offset:2048 lds
    v_sin_f32 v91, v87
    v_cvt_pk_bf16_f32 v56, v88, v89
    v_cvt_pk_bf16_f32 v64, -v90, -v91
    s_waitcnt lgkmcnt(4)
    v_mfma_f32_32x32x16_bf16 v[144:159], v[132:135], v[124:127], v[144:159]
    v_fmamk_f32 v86, v84, 0x40000000, v85
    v_fmamk_f32 v87, v84, 0x40400000, v85
    v_cos_f32 v88, v86
    s_waitcnt lgkmcnt(3)
    v_mfma_f32_32x32x16_bf16 v[160:175], v[132:135], v[128:131], v[160:175]
    s_waitcnt lgkmcnt(0)
    s_waitcnt vmcnt(17)
    s_barrier
    ds_read_b64_tr_b16 v[112:113], v37 offset:0
    ds_read_b64_tr_b16 v[114:115], v37 offset:512
    ds_read_b128 v[104:107], v13 offset:0
    ds_read_b128 v[108:111], v21 offset:0
    v_mfma_f32_32x32x16_bf16 v[192:207], v[136:139], v[128:131], v[192:207]
    ds_read_b64_tr_b16 v[116:117], v39 offset:0
    ds_read_b64_tr_b16 v[118:119], v39 offset:512
    ds_read_b128 v[120:123], v29 offset:0
    s_lshl_b32 s74, s63, 9
    buffer_load_dwordx4 v[224:227], v42, s[44:47], s74 offen sc1
    v_mfma_f32_32x32x16_bf16 v[176:191], v[136:139], v[124:127], v[176:191]
    s_xor_b32 s74, s74, 512
    buffer_load_dwordx4 v[228:231], v42, s[44:47], s74 offen sc1
    v_cos_f32 v89, v87
    v_mfma_f32_32x32x16_bf16 v[208:223], v[124:127], v[140:143], v[208:223]
    s_lshl_b32 s74, s62, 11
    s_lshl_b32 s75, s60, 10
    s_add_u32 s74, s74, s75
    s_lshl_b32 s75, s59, 9
    s_add_u32 s74, s74, s75
    s_add_u32 s74, s74, 32768
    buffer_load_dwordx4 v[232:235], v42, s[44:47], s74 offen sc1
    s_xor_b32 s74, s74, 512
    buffer_load_dwordx4 v[236:239], v42, s[44:47], s74 offen sc1
    s_lshl_b32 s74, s62, 9
    s_add_u32 s74, s74, 98304
    buffer_load_dwordx4 v[100:103], v42, s[44:47], s74 offen sc1
    buffer_load_dwordx4 v11, s[28:31], s73 offen offset:3072 lds
    s_waitcnt lgkmcnt(4)
    v_mfma_f32_32x32x16_bf16 v[144:159], v[112:115], v[104:107], v[144:159]
    ds_read_b64_tr_b16 v[132:133], v37 offset:2048
    ds_read_b64_tr_b16 v[134:135], v37 offset:2560
    ds_read_b128 v[124:127], v14 offset:0
    v_sin_f32 v90, v86
    s_waitcnt lgkmcnt(6)
    v_mfma_f32_32x32x16_bf16 v[160:175], v[112:115], v[108:111], v[160:175]
    ds_read_b128 v[128:131], v22 offset:0
    ds_read_b64_tr_b16 v[136:137], v39 offset:2048
    ds_read_b64_tr_b16 v[138:139], v39 offset:2560
    v_sin_f32 v91, v87
    s_waitcnt lgkmcnt(7)
    v_mfma_f32_32x32x16_bf16 v[192:207], v[116:119], v[108:111], v[192:207]
    ds_read_b128 v[140:143], v30 offset:0
    s_mov_b32 s7, s81
    s_mul_i32 s76, s7, 57344
    s_add_u32 m0, s11, 110592
    s_nop 0
    buffer_load_dwordx4 v48, s[48:51], s76 offen offset:0 lds
    v_mfma_f32_32x32x16_bf16 v[176:191], v[116:119], v[104:107], v[176:191]
    v_cvt_pk_bf16_f32 v57, v88, v89
    v_cvt_pk_bf16_f32 v65, -v90, -v91
    v_fmamk_f32 v86, v84, 0x41000000, v85
    v_fmamk_f32 v87, v84, 0x41100000, v85
    s_waitcnt lgkmcnt(7)
    v_mfma_f32_32x32x16_bf16 v[208:223], v[104:107], v[120:123], v[208:223]
    v_cos_f32 v88, v86
    v_cos_f32 v89, v87
    s_waitcnt lgkmcnt(4)
    v_mfma_f32_32x32x16_bf16 v[144:159], v[132:135], v[124:127], v[144:159]
    ds_read_b64_tr_b16 v[112:113], v37 offset:4096
    ds_read_b64_tr_b16 v[114:115], v37 offset:4608
    ds_read_b128 v[104:107], v15 offset:0
    v_sin_f32 v90, v86
    s_waitcnt lgkmcnt(6)
    v_mfma_f32_32x32x16_bf16 v[160:175], v[132:135], v[128:131], v[160:175]
    ds_read_b128 v[108:111], v23 offset:0
    ds_read_b64_tr_b16 v[116:117], v39 offset:4096
    ds_read_b64_tr_b16 v[118:119], v39 offset:4608
    v_sin_f32 v91, v87
    s_waitcnt lgkmcnt(7)
    v_mfma_f32_32x32x16_bf16 v[192:207], v[136:139], v[128:131], v[192:207]
    ds_read_b128 v[120:123], v31 offset:0
    s_add_u32 m0, s11, 110592
    s_nop 0
    buffer_load_dwordx4 v49, s[48:51], s76 offen offset:1024 lds
    v_cvt_pk_bf16_f32 v58, v88, v89
    v_mfma_f32_32x32x16_bf16 v[176:191], v[136:139], v[124:127], v[176:191]
    s_add_u32 m0, s11, 110592
    s_nop 0
    buffer_load_dwordx4 v50, s[48:51], s76 offen offset:2048 lds
    v_cvt_pk_bf16_f32 v66, -v90, -v91
    v_fmamk_f32 v86, v84, 0x41200000, v85
    s_waitcnt lgkmcnt(7)
    v_mfma_f32_32x32x16_bf16 v[208:223], v[124:127], v[140:143], v[208:223]
    v_fmamk_f32 v87, v84, 0x41300000, v85
    v_cos_f32 v88, v86
    v_cos_f32 v89, v87
    s_waitcnt lgkmcnt(4)
    v_mfma_f32_32x32x16_bf16 v[144:159], v[112:115], v[104:107], v[144:159]
    ds_read_b64_tr_b16 v[132:133], v37 offset:6144
    ds_read_b64_tr_b16 v[134:135], v37 offset:6656
    ds_read_b128 v[124:127], v16 offset:0
    v_sin_f32 v90, v86
    s_waitcnt lgkmcnt(6)
    v_mfma_f32_32x32x16_bf16 v[160:175], v[112:115], v[108:111], v[160:175]
    ds_read_b128 v[128:131], v24 offset:0
    ds_read_b64_tr_b16 v[136:137], v39 offset:6144
    ds_read_b64_tr_b16 v[138:139], v39 offset:6656
    v_sin_f32 v91, v87
    s_waitcnt lgkmcnt(7)
    v_mfma_f32_32x32x16_bf16 v[192:207], v[116:119], v[108:111], v[192:207]
    ds_read_b128 v[140:143], v32 offset:0
    s_add_u32 m0, s11, 110592
    s_nop 0
    buffer_load_dwordx4 v51, s[48:51], s76 offen offset:3072 lds
    v_cvt_pk_bf16_f32 v59, v88, v89
    v_mfma_f32_32x32x16_bf16 v[176:191], v[116:119], v[104:107], v[176:191]
    v_cvt_pk_bf16_f32 v67, -v90, -v91
    v_fmamk_f32 v86, v84, 0x41800000, v85
    v_fmamk_f32 v87, v84, 0x41880000, v85
    v_cos_f32 v88, v86
    s_waitcnt lgkmcnt(7)
    v_mfma_f32_32x32x16_bf16 v[208:223], v[104:107], v[120:123], v[208:223]
    v_cos_f32 v89, v87
    v_sin_f32 v90, v86
    s_waitcnt lgkmcnt(4)
    v_mfma_f32_32x32x16_bf16 v[144:159], v[132:135], v[124:127], v[144:159]
    v_sin_f32 v91, v87
    v_cvt_pk_bf16_f32 v60, v88, v89
    v_cvt_pk_bf16_f32 v68, -v90, -v91
    v_fmamk_f32 v86, v84, 0x41900000, v85
    s_waitcnt lgkmcnt(3)
    v_mfma_f32_32x32x16_bf16 v[160:175], v[132:135], v[128:131], v[160:175]
    s_waitcnt lgkmcnt(0)
    s_waitcnt vmcnt(18)
    s_barrier
    ds_read_b64_tr_b16 v[112:113], v37 offset:36864
    ds_read_b64_tr_b16 v[114:115], v37 offset:37376
    ds_read_b128 v[104:107], v13 offset:36864
    ds_read_b128 v[108:111], v21 offset:36864
    v_mfma_f32_32x32x16_bf16 v[192:207], v[136:139], v[128:131], v[192:207]
    ds_read_b64_tr_b16 v[116:117], v39 offset:36864
    ds_read_b64_tr_b16 v[118:119], v39 offset:37376
    ds_read_b128 v[120:123], v29 offset:36864
    s_add_u32 s76, s76, 28672
    s_add_u32 m0, s11, 114688
    s_nop 0
    buffer_load_dwordx4 v48, s[48:51], s76 offen offset:0 lds
    v_mfma_f32_32x32x16_bf16 v[176:191], v[136:139], v[124:127], v[176:191]
    v_fmamk_f32 v87, v84, 0x41980000, v85
    v_cos_f32 v88, v86
    v_cos_f32 v89, v87
    v_mfma_f32_32x32x16_bf16 v[208:223], v[124:127], v[140:143], v[208:223]
    v_sin_f32 v90, v86
    v_sin_f32 v91, v87
    v_cvt_pk_bf16_f32 v61, v88, v89
    s_waitcnt lgkmcnt(4)
    v_mfma_f32_32x32x16_bf16 v[144:159], v[112:115], v[104:107], v[144:159]
    ds_read_b64_tr_b16 v[132:133], v37 offset:38912
    ds_read_b64_tr_b16 v[134:135], v37 offset:39424
    ds_read_b128 v[124:127], v14 offset:36864
    v_cvt_pk_bf16_f32 v69, -v90, -v91
    v_fmamk_f32 v86, v84, 0x41c00000, v85
    s_waitcnt lgkmcnt(6)
    v_mfma_f32_32x32x16_bf16 v[160:175], v[112:115], v[108:111], v[160:175]
    ds_read_b128 v[128:131], v22 offset:36864
    ds_read_b64_tr_b16 v[136:137], v39 offset:38912
    ds_read_b64_tr_b16 v[138:139], v39 offset:39424
    v_fmamk_f32 v87, v84, 0x41c80000, v85
    s_waitcnt lgkmcnt(7)
    v_mfma_f32_32x32x16_bf16 v[192:207], v[116:119], v[108:111], v[192:207]
    ds_read_b128 v[140:143], v30 offset:36864
    s_add_u32 m0, s11, 114688
    s_nop 0
    buffer_load_dwordx4 v49, s[48:51], s76 offen offset:1024 lds
    v_mfma_f32_32x32x16_bf16 v[176:191], v[116:119], v[104:107], v[176:191]
    s_add_u32 m0, s11, 114688
    s_nop 0
    buffer_load_dwordx4 v50, s[48:51], s76 offen offset:2048 lds
    v_cos_f32 v88, v86
    s_waitcnt lgkmcnt(7)
    v_mfma_f32_32x32x16_bf16 v[208:223], v[104:107], v[120:123], v[208:223]
    v_cos_f32 v89, v87
    v_sin_f32 v90, v86
    s_waitcnt lgkmcnt(4)
    v_mfma_f32_32x32x16_bf16 v[144:159], v[132:135], v[124:127], v[144:159]
    s_waitcnt vmcnt(8)
    v_cmp_ne_u64 vcc, s[56:57], v[226:227]
    v_cmp_ne_u64 s[22:23], s[56:57], v[230:231]
    s_or_b64 vcc, vcc, s[22:23]
    v_cmp_ne_u64 s[22:23], s[56:57], v[234:235]
    s_or_b64 vcc, vcc, s[22:23]
    v_cmp_ne_u64 s[22:23], s[56:57], v[238:239]
    s_or_b64 vcc, vcc, s[22:23]
    v_cmp_ne_u64 s[22:23], s[56:57], v[102:103]
    s_or_b64 vcc, vcc, s[22:23]
    s_cbranch_vccz Lok_1
    s_mov_b32 s78, 131072
Lspin_2:
    s_lshl_b32 s74, s63, 9
    buffer_load_dwordx4 v[224:227], v42, s[44:47], s74 offen sc1
    s_xor_b32 s74, s74, 512
    buffer_load_dwordx4 v[228:231], v42, s[44:47], s74 offen sc1
    s_lshl_b32 s74, s62, 11
    s_lshl_b32 s75, s60, 10
    s_add_u32 s74, s74, s75
    s_lshl_b32 s75, s59, 9
    s_add_u32 s74, s74, s75
    s_add_u32 s74, s74, 32768
    buffer_load_dwordx4 v[232:235], v42, s[44:47], s74 offen sc1
    s_xor_b32 s74, s74, 512
    buffer_load_dwordx4 v[236:239], v42, s[44:47], s74 offen sc1
    s_lshl_b32 s74, s62, 9
    s_add_u32 s74, s74, 98304
    buffer_load_dwordx4 v[100:103], v42, s[44:47], s74 offen sc1
    s_sub_u32 s78, s78, 1
    s_cbranch_scc1 Lok_1
    s_waitcnt vmcnt(0)
    v_cmp_ne_u64 vcc, s[56:57], v[226:227]
    v_cmp_ne_u64 s[22:23], s[56:57], v[230:231]
    s_or_b64 vcc, vcc, s[22:23]
    v_cmp_ne_u64 s[22:23], s[56:57], v[234:235]
    s_or_b64 vcc, vcc, s[22:23]
    v_cmp_ne_u64 s[22:23], s[56:57], v[238:239]
    s_or_b64 vcc, vcc, s[22:23]
    v_cmp_ne_u64 s[22:23], s[56:57], v[102:103]
    s_or_b64 vcc, vcc, s[22:23]
    s_cbranch_vccnz Lspin_2
Lok_1:
    ds_read_b64_tr_b16 v[112:113], v37 offset:40960
    ds_read_b64_tr_b16 v[114:115], v37 offset:41472
    ds_read_b128 v[104:107], v15 offset:36864
    s_waitcnt lgkmcnt(6)
    v_mfma_f32_32x32x16_bf16 v[160:175], v[132:135], v[128:131], v[160:175]
    ds_read_b128 v[108:111], v23 offset:36864
    ds_read_b64_tr_b16 v[116:117], v39 offset:40960
    ds_read_b64_tr_b16 v[118:119], v39 offset:41472
    ds_write_b32 v44, v225
    v_and_b32 v224, v224, v41
    s_waitcnt lgkmcnt(8)
    v_mfma_f32_32x32x16_bf16 v[192:207], v[136:139], v[128:131], v[192:207]
    ds_read_b128 v[120:123], v31 offset:36864
    s_add_u32 m0, s11, 114688
    s_nop 0
    buffer_load_dwordx4 v51, s[48:51], s76 offen offset:3072 lds
    v_and_b32 v225, 0xffff, v224
    v_mfma_f32_32x32x16_bf16 v[176:191], v[136:139], v[124:127], v[176:191]
    v_mov_b32 v226, 0
    v_mov_b32 v227, 0
    v_and_b32 v228, v228, v41
    v_and_b32 v229, 0xffff, v228
    v_mov_b32 v230, 0
    s_waitcnt lgkmcnt(8)
    v_mfma_f32_32x32x16_bf16 v[208:223], v[124:127], v[140:143], v[208:223]
    v_mov_b32 v231, 0
    v_mov_b32 v234, 0
    v_mov_b32 v235, 0
    v_mov_b32 v238, 0
    v_mov_b32 v239, 0
    s_waitcnt lgkmcnt(5)
    v_mfma_f32_32x32x16_bf16 v[144:159], v[112:115], v[104:107], v[144:159]
    ds_read_b64_tr_b16 v[132:133], v37 offset:43008
    ds_read_b64_tr_b16 v[134:135], v37 offset:43520
    ds_read_b128 v[124:127], v16 offset:36864
    v_mov_b32 v102, 0
    v_mov_b32 v103, 0
    s_waitcnt lgkmcnt(7)
    v_mfma_f32_32x32x16_bf16 v[160:175], v[112:115], v[108:111], v[160:175]
    ds_read_b128 v[128:131], v24 offset:36864
    ds_read_b64_tr_b16 v[136:137], v39 offset:43008
    ds_read_b64_tr_b16 v[138:139], v39 offset:43520
    ds_read_b128 v[240:243], v43 offset:0
    ds_read_b128 v[244:247], v43 offset:32
    s_waitcnt lgkmcnt(10)
    v_mfma_f32_32x32x16_bf16 v[192:207], v[116:119], v[108:111], v[192:207]
    ds_read_b128 v[140:143], v32 offset:36864
    s_add_u32 s7, s7, 1
    s_cmp_eq_u32 s7, 7
    s_cselect_b32 s7, 0, s7
    s_mul_i32 s76, s7, 57344
    s_add_u32 m0, s11, 0
    s_nop 0
    buffer_load_dwordx4 v48, s[48:51], s76 offen offset:0 lds
    v_mfma_f32_32x32x16_bf16 v[176:191], v[116:119], v[104:107], v[176:191]
    ds_read_b128 v[248:251], v43 offset:64
    ds_read_b128 v[252:255], v43 offset:96
    v_sin_f32 v91, v87
    v_cvt_pk_bf16_f32 v62, v88, v89
    s_waitcnt lgkmcnt(11)
    v_mfma_f32_32x32x16_bf16 v[208:223], v[104:107], v[120:123], v[208:223]
    v_cvt_pk_bf16_f32 v70, -v90, -v91
    v_fmamk_f32 v86, v84, 0x41d00000, v85
    v_fmamk_f32 v87, v84, 0x41d80000, v85
    v_cos_f32 v88, v86
    s_waitcnt lgkmcnt(8)
    v_mfma_f32_32x32x16_bf16 v[144:159], v[132:135], v[124:127], v[144:159]
    v_cos_f32 v89, v87
    v_sin_f32 v90, v86
    s_waitcnt lgkmcnt(7)
    v_mfma_f32_32x32x16_bf16 v[160:175], v[132:135], v[128:131], v[160:175]
    s_waitcnt lgkmcnt(0)
    s_waitcnt vmcnt(9)
    s_barrier
    ds_read_b64_tr_b16 v[112:113], v38 offset:0
    ds_read_b64_tr_b16 v[114:115], v38 offset:512
    ds_read_b128 v[104:107], v17 offset:0
    ds_read_b128 v[108:111], v25 offset:0
    v_mfma_f32_32x32x16_bf16 v[192:207], v[136:139], v[128:131], v[192:207]
    ds_read_b64_tr_b16 v[116:117], v40 offset:0
    ds_read_b64_tr_b16 v[118:119], v40 offset:512
    ds_read_b128 v[120:123], v33 offset:0
    s_add_u32 m0, s11, 0
    s_nop 0
    buffer_load_dwordx4 v49, s[48:51], s76 offen offset:1024 lds
    v_mfma_f32_32x32x16_bf16 v[176:191], v[136:139], v[124:127], v[176:191]
    s_add_u32 m0, s11, 0
    s_nop 0
    buffer_load_dwordx4 v50, s[48:51], s76 offen offset:2048 lds
    v_sin_f32 v91, v87
    v_mfma_f32_32x32x16_bf16 v[208:223], v[124:127], v[140:143], v[208:223]
    v_cvt_pk_bf16_f32 v63, v88, v89
    v_cvt_pk_bf16_f32 v71, -v90, -v91
    s_lshl_b32 s79, s62, 4
    s_add_u32 s79, s79, s61
    s_lshl_b32 s79, s79, 3
    s_add_u32 s79, s79, 69632
    s_waitcnt lgkmcnt(4)
    v_mfma_f32_32x32x16_bf16 v[144:159], v[112:115], v[104:107], v[144:159]
    ds_read_b64_tr_b16 v[132:133], v38 offset:2048
    ds_read_b64_tr_b16 v[134:135], v38 offset:2560
    ds_read_b128 v[124:127], v18 offset:0
    s_waitcnt lgkmcnt(6)
    v_mfma_f32_32x32x16_bf16 v[160:175], v[112:115], v[108:111], v[160:175]
    ds_read_b128 v[128:131], v26 offset:0
    ds_read_b64_tr_b16 v[136:137], v40 offset:2048
    ds_read_b64_tr_b16 v[138:139], v40 offset:2560
    s_waitcnt lgkmcnt(7)
    v_mfma_f32_32x32x16_bf16 v[192:207], v[116:119], v[108:111], v[192:207]
    ds_read_b128 v[140:143], v34 offset:0
    s_add_u32 m0, s11, 0
    s_nop 0
    buffer_load_dwordx4 v51, s[48:51], s76 offen offset:3072 lds
    v_mfma_f32_32x32x16_bf16 v[176:191], v[116:119], v[104:107], v[176:191]
    s_lshl_b32 s80, s61, 4
    s_add_u32 s80, s80, s62
    s_lshl_b32 s80, s80, 3
    s_add_u32 s80, s80, 65536
    s_sub_u32 s80, s80, s79
    s_waitcnt lgkmcnt(7)
    v_mfma_f32_32x32x16_bf16 v[208:223], v[104:107], v[120:123], v[208:223]
    v_mul_lo_u32 v94, v1, s80
    v_add_u32 v94, s79, v94
    v_mov_b32 v92, s56
    v_mov_b32 v93, s57
    s_waitcnt lgkmcnt(4)
    v_mfma_f32_32x32x16_bf16 v[144:159], v[132:135], v[124:127], v[144:159]
    ds_read_b64_tr_b16 v[112:113], v38 offset:4096
    ds_read_b64_tr_b16 v[114:115], v38 offset:4608
    ds_read_b128 v[104:107], v19 offset:0
    s_waitcnt lgkmcnt(6)
    v_mfma_f32_32x32x16_bf16 v[160:175], v[132:135], v[128:131], v[160:175]
    ds_read_b128 v[108:111], v27 offset:0
    ds_read_b64_tr_b16 v[116:117], v40 offset:4096
    ds_read_b64_tr_b16 v[118:119], v40 offset:4608
    s_waitcnt lgkmcnt(7)
    v_mfma_f32_32x32x16_bf16 v[192:207], v[136:139], v[128:131], v[192:207]
    ds_read_b128 v[120:123], v35 offset:0
    s_add_u32 s76, s76, 28672
    s_add_u32 m0, s11, 4096
    s_nop 0
    buffer_load_dwordx4 v48, s[48:51], s76 offen offset:0 lds
    v_mfma_f32_32x32x16_bf16 v[176:191], v[136:139], v[124:127], v[176:191]
    s_waitcnt lgkmcnt(7)
    v_mfma_f32_32x32x16_bf16 v[208:223], v[124:127], v[140:143], v[208:223]
    s_waitcnt lgkmcnt(4)
    v_mfma_f32_32x32x16_bf16 v[144:159], v[112:115], v[104:107], v[144:159]
    ds_read_b64_tr_b16 v[132:133], v38 offset:6144
    ds_read_b64_tr_b16 v[134:135], v38 offset:6656
    ds_read_b128 v[124:127], v20 offset:0
    s_waitcnt lgkmcnt(6)
    v_mfma_f32_32x32x16_bf16 v[160:175], v[112:115], v[108:111], v[160:175]
    ds_read_b128 v[128:131], v28 offset:0
    ds_read_b64_tr_b16 v[136:137], v40 offset:6144
    ds_read_b64_tr_b16 v[138:139], v40 offset:6656
    s_waitcnt lgkmcnt(7)
    v_mfma_f32_32x32x16_bf16 v[192:207], v[116:119], v[108:111], v[192:207]
    ds_read_b128 v[140:143], v36 offset:0
    s_add_u32 m0, s11, 4096
    s_nop 0
    buffer_load_dwordx4 v49, s[48:51], s76 offen offset:1024 lds
    v_mfma_f32_32x32x16_bf16 v[176:191], v[116:119], v[104:107], v[176:191]
    s_add_u32 m0, s11, 4096
    s_nop 0
    buffer_load_dwordx4 v50, s[48:51], s76 offen offset:2048 lds
    s_waitcnt lgkmcnt(7)
    v_mfma_f32_32x32x16_bf16 v[208:223], v[104:107], v[120:123], v[208:223]
    v_mfma_f32_32x32x16_bf16 v[144:159], v[232:235], v[224:227], v[144:159]
    v_mfma_f32_32x32x16_bf16 v[160:175], v[232:235], v[228:231], v[160:175]
    v_mfma_f32_32x32x16_bf16 v[176:191], v[236:239], v[224:227], v[176:191]
    v_mfma_f32_32x32x16_bf16 v[192:207], v[236:239], v[228:231], v[192:207]
    v_mfma_f32_32x32x16_bf16 v[208:223], v[224:227], v[100:103], v[208:223]
    s_waitcnt lgkmcnt(4)
    v_mfma_f32_32x32x16_bf16 v[144:159], v[132:135], v[124:127], v[144:159]
    s_waitcnt lgkmcnt(3)
    v_mfma_f32_32x32x16_bf16 v[160:175], v[132:135], v[128:131], v[160:175]
    s_waitcnt lgkmcnt(1)
    v_mfma_f32_32x32x16_bf16 v[192:207], v[136:139], v[128:131], v[192:207]
    s_add_u32 m0, s11, 4096
    s_nop 0
    buffer_load_dwordx4 v51, s[48:51], s76 offen offset:3072 lds
    v_mfma_f32_32x32x16_bf16 v[176:191], v[136:139], v[124:127], v[176:191]
    s_waitcnt lgkmcnt(0)
    v_mfma_f32_32x32x16_bf16 v[208:223], v[124:127], v[140:143], v[208:223]
    s_nop 6
    s_waitcnt lgkmcnt(0)
    v_cvt_pk_bf16_f32 v144, v144, v145
    v_cvt_pk_bf16_f32 v145, v146, v147
    v_cvt_pk_bf16_f32 v146, v148, v149
    v_cvt_pk_bf16_f32 v147, v150, v151
    v_cvt_pk_bf16_f32 v148, v152, v153
    v_cvt_pk_bf16_f32 v149, v154, v155
    v_cvt_pk_bf16_f32 v150, v156, v157
    v_cvt_pk_bf16_f32 v151, v158, v159
    v_pk_max_i16 v144, v144, 0
    v_pk_max_i16 v145, v145, 0
    v_pk_max_i16 v146, v146, 0
    v_pk_max_i16 v147, v147, 0
    v_pk_max_i16 v148, v148, 0
    v_pk_max_i16 v149, v149, 0
    v_pk_max_i16 v150, v150, 0
    v_pk_max_i16 v151, v151, 0
    buffer_store_dwordx4 v[144:147], v82, s[36:39], s4 offen sc1
    buffer_store_dwordx4 v[148:151], v82, s[36:39], s4 offen offset:1024 sc1
    v_mul_f32 v208, v208, v240
    v_mul_f32 v209, v209, v241
    v_mul_f32 v210, v210, v242
    v_mul_f32 v211, v211, v243
    v_mul_f32 v212, v212, v244
    v_mul_f32 v213, v213, v245
    v_mul_f32 v214, v214, v246
    v_mul_f32 v215, v215, v247
    v_mul_f32 v216, v216, v248
    v_mul_f32 v217, v217, v249
    v_mul_f32 v218, v218, v250
    v_mul_f32 v219, v219, v251
    v_mul_f32 v220, v220, v252
    v_mul_f32 v221, v221, v253
    v_mul_f32 v222, v222, v254
    v_mul_f32 v223, v223, v255
    v_cvt_pk_bf16_f32 v104, v208, v209
    v_cvt_pk_bf16_f32 v105, v210, v211
    v_cvt_pk_bf16_f32 v106, v212, v213
    v_cvt_pk_bf16_f32 v107, v214, v215
    v_cvt_pk_bf16_f32 v108, v216, v217
    v_cvt_pk_bf16_f32 v109, v218, v219
    v_cvt_pk_bf16_f32 v110, v220, v221
    v_cvt_pk_bf16_f32 v111, v222, v223
    ds_swizzle_b32 v112, v104 offset:0x401f
    ds_swizzle_b32 v113, v105 offset:0x401f
    ds_swizzle_b32 v114, v106 offset:0x401f
    ds_swizzle_b32 v115, v107 offset:0x401f
    ds_swizzle_b32 v116, v108 offset:0x401f
    ds_swizzle_b32 v117, v109 offset:0x401f
    ds_swizzle_b32 v118, v110 offset:0x401f
    ds_swizzle_b32 v119, v111 offset:0x401f
    v_mfma_f32_32x32x16_bf16 v[208:223], v[56:59], v[104:107], 0
    v_mfma_f32_32x32x16_bf16 v[208:223], v[60:63], v[108:111], v[208:223]
    v_cvt_pk_bf16_f32 v160, v160, v161
    v_cvt_pk_bf16_f32 v161, v162, v163
    v_cvt_pk_bf16_f32 v162, v164, v165
    v_cvt_pk_bf16_f32 v163, v166, v167
    v_cvt_pk_bf16_f32 v164, v168, v169
    v_cvt_pk_bf16_f32 v165, v170, v171
    v_cvt_pk_bf16_f32 v166, v172, v173
    v_cvt_pk_bf16_f32 v167, v174, v175
    v_pk_max_i16 v160, v160, 0
    v_pk_max_i16 v161, v161, 0
    v_pk_max_i16 v162, v162, 0
    v_pk_max_i16 v163, v163, 0
    v_pk_max_i16 v164, v164, 0
    v_pk_max_i16 v165, v165, 0
    v_pk_max_i16 v166, v166, 0
    v_pk_max_i16 v167, v167, 0
    buffer_store_dwordx4 v[160:163], v82, s[36:39], s5 offen sc1
    buffer_store_dwordx4 v[164:167], v82, s[36:39], s5 offen offset:1024 sc1
    s_waitcnt lgkmcnt(0)
    v_xor_b32 v112, v112, v78
    v_xor_b32 v113, v113, v78
    v_xor_b32 v114, v114, v78
    v_xor_b32 v115, v115, v78
    v_xor_b32 v116, v116, v78
    v_xor_b32 v117, v117, v78
    v_xor_b32 v118, v118, v78
    v_xor_b32 v119, v119, v78
    s_nop 1
    v_mfma_f32_32x32x16_bf16 v[208:223], v[64:67], v[112:115], v[208:223]
    v_mfma_f32_32x32x16_bf16 v[208:223], v[68:71], v[116:119], v[208:223]
    v_cvt_pk_bf16_f32 v176, v176, v177
    v_cvt_pk_bf16_f32 v177, v178, v179
    v_cvt_pk_bf16_f32 v178, v180, v181
    v_cvt_pk_bf16_f32 v179, v182, v183
    v_cvt_pk_bf16_f32 v180, v184, v185
    v_cvt_pk_bf16_f32 v181, v186, v187
    v_cvt_pk_bf16_f32 v182, v188, v189
    v_cvt_pk_bf16_f32 v183, v190, v191
    v_pk_max_i16 v176, v176, 0
    v_pk_max_i16 v177, v177, 0
    v_pk_max_i16 v178, v178, 0
    v_pk_max_i16 v179, v179, 0
    v_pk_max_i16 v180, v180, 0
    v_pk_max_i16 v181, v181, 0
    v_pk_max_i16 v182, v182, 0
    v_pk_max_i16 v183, v183, 0
    buffer_store_dwordx4 v[176:179], v82, s[36:39], s8 offen sc1
    buffer_store_dwordx4 v[180:183], v82, s[36:39], s8 offen offset:1024 sc1
    v_permlane16_swap_b32 v208, v209
    v_permlane16_swap_b32 v210, v211
    v_permlane16_swap_b32 v212, v213
    v_permlane16_swap_b32 v214, v215
    v_permlane16_swap_b32 v216, v217
    v_permlane16_swap_b32 v218, v219
    v_permlane16_swap_b32 v220, v221
    v_permlane16_swap_b32 v222, v223
    s_nop 1
    v_cvt_pk_bf16_f32 v104, v208, v209
    v_cvt_pk_bf16_f32 v105, v210, v211
    v_cvt_pk_bf16_f32 v106, v212, v213
    v_cvt_pk_bf16_f32 v107, v214, v215
    v_cvt_pk_bf16_f32 v108, v216, v217
    v_cvt_pk_bf16_f32 v109, v218, v219
    v_cvt_pk_bf16_f32 v110, v220, v221
    v_cvt_pk_bf16_f32 v111, v222, v223
    ds_write_b32 v79, v104 offset:0
    ds_write_b32 v79, v105 offset:512
    ds_write_b32 v79, v106 offset:2048
    ds_write_b32 v79, v107 offset:2560
    ds_write_b32 v79, v108 offset:4096
    ds_write_b32 v79, v109 offset:4608
    ds_write_b32 v79, v110 offset:6144
    ds_write_b32 v79, v111 offset:6656
    v_cvt_pk_bf16_f32 v192, v192, v193
    v_cvt_pk_bf16_f32 v193, v194, v195
    v_cvt_pk_bf16_f32 v194, v196, v197
    v_cvt_pk_bf16_f32 v195, v198, v199
    v_cvt_pk_bf16_f32 v196, v200, v201
    v_cvt_pk_bf16_f32 v197, v202, v203
    v_cvt_pk_bf16_f32 v198, v204, v205
    v_cvt_pk_bf16_f32 v199, v206, v207
    v_pk_max_i16 v192, v192, 0
    v_pk_max_i16 v193, v193, 0
    v_pk_max_i16 v194, v194, 0
    v_pk_max_i16 v195, v195, 0
    v_pk_max_i16 v196, v196, 0
    v_pk_max_i16 v197, v197, 0
    v_pk_max_i16 v198, v198, 0
    v_pk_max_i16 v199, v199, 0
    buffer_store_dwordx4 v[192:195], v82, s[36:39], s9 offen sc1
    buffer_store_dwordx4 v[196:199], v82, s[36:39], s9 offen offset:1024 sc1
    s_waitcnt lgkmcnt(0)
    s_barrier
    ds_read_b128 v[112:115], v80
    ds_read_b128 v[116:119], v80 offset:1024
    s_mov_b32 s67, 262144
    s_waitcnt lgkmcnt(0)
    buffer_store_dwordx4 v[112:115], v81, s[40:43], 0 offen sc1
    buffer_store_dwordx4 v[116:119], v81, s[40:43], s67 offen sc1
    s_waitcnt vmcnt(18)
    ds_read_b64_tr_b16 a[0:1], v54 offset:0
    ds_read_b64_tr_b16 a[2:3], v54 offset:1024
    ds_read_b64_tr_b16 a[4:5], v73 offset:0
    ds_read_b64_tr_b16 a[6:7], v73 offset:1024
    ds_read_b64_tr_b16 a[8:9], v54 offset:2048
    ds_read_b64_tr_b16 a[10:11], v54 offset:3072
    ds_read_b64_tr_b16 a[12:13], v73 offset:2048
    ds_read_b64_tr_b16 a[14:15], v73 offset:3072
    ds_read_b64_tr_b16 a[16:17], v54 offset:4096
    ds_read_b64_tr_b16 a[18:19], v54 offset:5120
    ds_read_b64_tr_b16 a[20:21], v73 offset:4096
    ds_read_b64_tr_b16 a[22:23], v73 offset:5120
    ds_read_b64_tr_b16 a[24:25], v54 offset:6144
    ds_read_b64_tr_b16 a[26:27], v54 offset:7168
    ds_read_b64_tr_b16 a[28:29], v73 offset:6144
    ds_read_b64_tr_b16 a[30:31], v73 offset:7168
    s_add_u32 s67, s70, 0
    v_lshl_add_u32 v56, v2, 6, s67
    v_lshl_add_u32 v57, v3, 1, s59
    v_cvt_f32_u32 v56, v56
    v_cvt_f32_u32 v57, v57
    v_mul_f32 v56, 0x3a000000, v56
    v_mul_f32 v57, 0x41000000, v57
    v_mul_f32 v57, v57, v56
    v_fmamk_f32 v58, v56, 0x00000000, v57
    v_fmamk_f32 v59, v56, 0x3f800000, v57
    v_cos_f32 v60, v58
    v_sin_f32 v61, v58
    v_cos_f32 v62, v59
    v_sin_f32 v63, v59
    v_cvt_pk_bf16_f32 v4, v60, v61
    v_cvt_pk_bf16_f32 v5, v62, v63
    v_fmamk_f32 v58, v56, 0x42000000, v57
    v_fmamk_f32 v59, v56, 0x42040000, v57
    v_cos_f32 v60, v58
    v_sin_f32 v61, v58
    v_cos_f32 v62, v59
    v_sin_f32 v63, v59
    v_cvt_pk_bf16_f32 v6, v60, v61
    v_cvt_pk_bf16_f32 v7, v62, v63
    v_fmamk_f32 v58, v56, 0x40000000, v57
    v_fmamk_f32 v59, v56, 0x40400000, v57
    v_cos_f32 v60, v58
    v_sin_f32 v61, v58
    v_cos_f32 v62, v59
    v_sin_f32 v63, v59
    v_cvt_pk_bf16_f32 v8, v60, v61
    v_cvt_pk_bf16_f32 v9, v62, v63
    v_fmamk_f32 v58, v56, 0x42080000, v57
    v_fmamk_f32 v59, v56, 0x420c0000, v57
    v_cos_f32 v60, v58
    v_sin_f32 v61, v58
    v_cos_f32 v62, v59
    v_sin_f32 v63, v59
    v_cvt_pk_bf16_f32 v10, v60, v61
    v_cvt_pk_bf16_f32 v11, v62, v63
    v_fmamk_f32 v58, v56, 0x40800000, v57
    v_fmamk_f32 v59, v56, 0x40a00000, v57
    v_cos_f32 v60, v58
    s_waitcnt vmcnt(10)
    ds_read_b64_tr_b16 a[32:33], v77 offset:0
    ds_read_b64_tr_b16 a[34:35], v77 offset:1024
    ds_read_b64_tr_b16 a[36:37], v83 offset:0
    ds_read_b64_tr_b16 a[38:39], v83 offset:1024
    ds_read_b64_tr_b16 a[40:41], v77 offset:2048
    ds_read_b64_tr_b16 a[42:43], v77 offset:3072
    ds_read_b64_tr_b16 a[44:45], v83 offset:2048
    ds_read_b64_tr_b16 a[46:47], v83 offset:3072
    ds_read_b64_tr_b16 a[48:49], v77 offset:4096
    ds_read_b64_tr_b16 a[50:51], v77 offset:5120
    ds_read_b64_tr_b16 a[52:53], v83 offset:4096
    ds_read_b64_tr_b16 a[54:55], v83 offset:5120
    ds_read_b64_tr_b16 a[56:57], v77 offset:6144
    ds_read_b64_tr_b16 a[58:59], v77 offset:7168
    ds_read_b64_tr_b16 a[60:61], v83 offset:6144
    ds_read_b64_tr_b16 a[62:63], v83 offset:7168
    v_sin_f32 v61, v58
    v_cos_f32 v62, v59
    v_sin_f32 v63, v59
    v_cvt_pk_bf16_f32 v12, v60, v61
    v_cvt_pk_bf16_f32 v13, v62, v63
    v_fmamk_f32 v58, v56, 0x42100000, v57
    v_fmamk_f32 v59, v56, 0x42140000, v57
    v_cos_f32 v60, v58
    v_sin_f32 v61, v58
    v_cos_f32 v62, v59
    v_sin_f32 v63, v59
    v_cvt_pk_bf16_f32 v14, v60, v61
    v_cvt_pk_bf16_f32 v15, v62, v63
    v_fmamk_f32 v58, v56, 0x40c00000, v57
    v_fmamk_f32 v59, v56, 0x40e00000, v57
    v_cos_f32 v60, v58
    v_sin_f32 v61, v58
    v_cos_f32 v62, v59
    v_sin_f32 v63, v59
    v_cvt_pk_bf16_f32 v16, v60, v61
    v_cvt_pk_bf16_f32 v17, v62, v63
    v_fmamk_f32 v58, v56, 0x42180000, v57
    v_fmamk_f32 v59, v56, 0x421c0000, v57
    v_cos_f32 v60, v58
    v_sin_f32 v61, v58
    v_cos_f32 v62, v59
    s_waitcnt lgkmcnt(0)
    s_waitcnt vmcnt(0)
    s_barrier
    s_cmp_lg_u32 s58, 0
    s_cbranch_scc1 Lnofl_3
    s_mov_b64 exec, 3
    buffer_store_dwordx2 v[92:93], v94, s[44:47], 0 offen sc1
    s_mov_b64 exec, -1
Lnofl_3:
    s_add_u32 s7, s7, 1
    s_cmp_eq_u32 s7, 7
    s_cselect_b32 s7, 0, s7
    s_mul_i32 s76, s7, 57344
    s_add_u32 m0, s20, 32768
    s_nop 0
    buffer_load_dwordx4 v48, s[48:51], s76 offen offset:0 lds
    buffer_load_dwordx4 v49, s[48:51], s76 offen offset:1024 lds
    buffer_load_dwordx4 v50, s[48:51], s76 offen offset:2048 lds
    buffer_load_dwordx4 v51, s[48:51], s76 offen offset:3072 lds
    s_add_u32 s76, s76, 28672
    s_add_u32 m0, s20, 36864
    s_nop 0
    buffer_load_dwordx4 v48, s[48:51], s76 offen offset:0 lds
    buffer_load_dwordx4 v49, s[48:51], s76 offen offset:1024 lds
    buffer_load_dwordx4 v50, s[48:51], s76 offen offset:2048 lds
    buffer_load_dwordx4 v51, s[48:51], s76 offen offset:3072 lds
    s_add_u32 s7, s7, 1
    s_cmp_eq_u32 s7, 7
    s_cselect_b32 s7, 0, s7
    s_mul_i32 s76, s7, 57344
    s_add_u32 m0, s20, 0
    s_nop 0
    buffer_load_dwordx4 v48, s[48:51], s76 offen offset:0 lds
    buffer_load_dwordx4 v49, s[48:51], s76 offen offset:1024 lds
    buffer_load_dwordx4 v50, s[48:51], s76 offen offset:2048 lds
    v_sin_f32 v63, v59
    v_cvt_pk_bf16_f32 v18, v60, v61
    v_cvt_pk_bf16_f32 v19, v62, v63
    s_add_u32 s67, s70, 32
    v_lshl_add_u32 v56, v2, 6, s67
    v_lshl_add_u32 v57, v3, 1, s59
    v_cvt_f32_u32 v56, v56
    buffer_load_dwordx4 v51, s[48:51], s76 offen offset:3072 lds
    v_cvt_f32_u32 v57, v57
    v_mul_f32 v56, 0x3a000000, v56
    v_mul_f32 v57, 0x41000000, v57
    v_mul_f32 v57, v57, v56
    v_fmamk_f32 v58, v56, 0x00000000, v57
    v_fmamk_f32 v59, v56, 0x3f800000, v57
    v_cos_f32 v60, v58
    s_add_u32 s76, s76, 28672
    s_add_u32 m0, s20, 4096
    s_nop 0
    buffer_load_dwordx4 v48, s[48:51], s76 offen offset:0 lds
    v_sin_f32 v61, v58
    v_cos_f32 v62, v59
    v_sin_f32 v63, v59
    v_cvt_pk_bf16_f32 v20, v60, v61
    v_cvt_pk_bf16_f32 v21, v62, v63
    buffer_load_dwordx4 v49, s[48:51], s76 offen offset:1024 lds
    v_fmamk_f32 v58, v56, 0x42000000, v57
    v_fmamk_f32 v59, v56, 0x42040000, v57
    v_cos_f32 v60, v58
    v_sin_f32 v61, v58
    v_cos_f32 v62, v59
    buffer_load_dwordx4 v50, s[48:51], s76 offen offset:2048 lds
    v_sin_f32 v63, v59
    v_cvt_pk_bf16_f32 v22, v60, v61
    v_cvt_pk_bf16_f32 v23, v62, v63
    v_fmamk_f32 v58, v56, 0x40000000, v57
    v_fmamk_f32 v59, v56, 0x40400000, v57
    v_cos_f32 v60, v58
    buffer_load_dwordx4 v51, s[48:51], s76 offen offset:3072 lds
    v_sin_f32 v61, v58
    v_cos_f32 v62, v59
    v_sin_f32 v63, v59
    v_cvt_pk_bf16_f32 v24, v60, v61
    v_cvt_pk_bf16_f32 v25, v62, v63
    s_add_u32 s7, s7, 1
    s_cmp_eq_u32 s7, 7
    s_cselect_b32 s7, 0, s7
    s_mul_i32 s76, s7, 57344
    s_add_u32 m0, s20, 8192
    s_nop 0
    buffer_load_dwordx4 v48, s[48:51], s76 offen offset:0 lds
    v_fmamk_f32 v58, v56, 0x42080000, v57
    v_fmamk_f32 v59, v56, 0x420c0000, v57
    v_cos_f32 v60, v58
    v_sin_f32 v61, v58
    v_cos_f32 v62, v59
    buffer_load_dwordx4 v49, s[48:51], s76 offen offset:1024 lds
    v_sin_f32 v63, v59
    v_cvt_pk_bf16_f32 v26, v60, v61
    v_cvt_pk_bf16_f32 v27, v62, v63
    v_fmamk_f32 v58, v56, 0x40800000, v57
    v_fmamk_f32 v59, v56, 0x40a00000, v57
    v_cos_f32 v60, v58
    buffer_load_dwordx4 v50, s[48:51], s76 offen offset:2048 lds
    v_sin_f32 v61, v58
    v_cos_f32 v62, v59
    v_sin_f32 v63, v59
    v_cvt_pk_bf16_f32 v28, v60, v61
    v_cvt_pk_bf16_f32 v29, v62, v63
    buffer_load_dwordx4 v51, s[48:51], s76 offen offset:3072 lds
    s_waitcnt vmcnt(12)
    ds_read_b64_tr_b16 a[64:65], v52 offset:32768
    ds_read_b64_tr_b16 a[66:67], v52 offset:33792
    ds_read_b64_tr_b16 a[68:69], v53 offset:32768
    ds_read_b64_tr_b16 a[70:71], v53 offset:33792
    ds_read_b64_tr_b16 a[72:73], v52 offset:34816
    ds_read_b64_tr_b16 a[74:75], v52 offset:35840
    ds_read_b64_tr_b16 a[76:77], v53 offset:34816
    ds_read_b64_tr_b16 a[78:79], v53 offset:35840
    s_add_u32 s76, s76, 28672
    s_add_u32 m0, s20, 12288
    s_nop 0
    buffer_load_dwordx4 v48, s[48:51], s76 offen offset:0 lds
    ds_read_b64_tr_b16 a[80:81], v52 offset:36864
    ds_read_b64_tr_b16 a[82:83], v52 offset:37888
    ds_read_b64_tr_b16 a[84:85], v53 offset:36864
    ds_read_b64_tr_b16 a[86:87], v53 offset:37888
    ds_read_b64_tr_b16 a[88:89], v52 offset:38912
    ds_read_b64_tr_b16 a[90:91], v52 offset:39936
    ds_read_b64_tr_b16 a[92:93], v53 offset:38912
    ds_read_b64_tr_b16 a[94:95], v53 offset:39936
    buffer_load_dwordx4 v49, s[48:51], s76 offen offset:1024 lds
    v_fmamk_f32 v58, v56, 0x42100000, v57
    v_fmamk_f32 v59, v56, 0x42140000, v57
    v_cos_f32 v60, v58
    v_sin_f32 v61, v58
    v_cos_f32 v62, v59
    buffer_load_dwordx4 v50, s[48:51], s76 offen offset:2048 lds
    v_sin_f32 v63, v59
    v_cvt_pk_bf16_f32 v30, v60, v61
    v_cvt_pk_bf16_f32 v31, v62, v63
    v_fmamk_f32 v58, v56, 0x40c00000, v57
    v_fmamk_f32 v59, v56, 0x40e00000, v57
    v_cos_f32 v60, v58
    buffer_load_dwordx4 v51, s[48:51], s76 offen offset:3072 lds
    v_sin_f32 v61, v58
    v_cos_f32 v62, v59
    v_sin_f32 v63, v59
    v_cvt_pk_bf16_f32 v32, v60, v61
    v_cvt_pk_bf16_f32 v33, v62, v63
    s_add_u32 s7, s7, 1
    s_cmp_eq_u32 s7, 7
    s_cselect_b32 s7, 0, s7
    s_mul_i32 s76, s7, 57344
    s_add_u32 m0, s20, 16384
    s_nop 0
    buffer_load_dwordx4 v48, s[48:51], s76 offen offset:0 lds
    v_fmamk_f32 v58, v56, 0x42180000, v57
    v_fmamk_f32 v59, v56, 0x421c0000, v57
    v_cos_f32 v60, v58
    v_sin_f32 v61, v58
    v_cos_f32 v62, v59
    buffer_load_dwordx4 v49, s[48:51], s76 offen offset:1024 lds
    v_sin_f32 v63, v59
    v_cvt_pk_bf16_f32 v34, v60, v61
    v_cvt_pk_bf16_f32 v35, v62, v63
    v_and_b32 v64, 7, v2
    v_xor_b32 v64, v64, v3
    v_lshlrev_b32 v65, 7, v2
    s_lshl_b32 s67, s60, 12
    s_add_u32 s68, s67, 32768
    s_add_u32 s67, s68, s20
    buffer_load_dwordx2 v[46:47], v55, s[44:47], 0 offen sc1
    buffer_load_dwordx4 v50, s[48:51], s76 offen offset:2048 lds
    v_add_u32 v65, s67, v65
    v_xor_b32 v66, 0, v64
    v_lshl_add_u32 v84, v66, 4, v65
    v_xor_b32 v88, 0x1000, v84
    v_xor_b32 v66, 2, v64
    v_lshl_add_u32 v85, v66, 4, v65
    v_xor_b32 v89, 0x1000, v85
    v_xor_b32 v66, 4, v64
    buffer_load_dwordx4 v51, s[48:51], s76 offen offset:3072 lds
    v_lshl_add_u32 v86, v66, 4, v65
    v_xor_b32 v90, 0x1000, v86
    v_xor_b32 v66, 6, v64
    v_lshl_add_u32 v87, v66, 4, v65
    v_xor_b32 v91, 0x1000, v87
    v_lshrrev_b32 v64, 2, v1
    v_and_b32 v65, 3, v1
    v_and_b32 v66, 7, v64
    s_add_u32 s76, s76, 28672
    s_add_u32 m0, s20, 20480
    s_nop 0
    buffer_load_dwordx4 v48, s[48:51], s76 offen offset:0 lds
    v_lshlrev_b32 v67, 1, v65
    v_xor_b32 v66, v66, v67
    v_lshlrev_b32 v66, 4, v66
    v_lshl_add_u32 v66, v64, 7, v66
    s_lshl_b32 s67, s59, 11
    s_add_u32 s68, s68, s67
    s_xor_b32 s67, s60, 0
    s_mul_i32 s67, s67, 40960
    s_add_u32 s67, s67, s68
    buffer_load_dwordx4 v49, s[48:51], s76 offen offset:1024 lds
    v_add_u32 v92, s67, v66
    v_xor_b32 v93, 16, v92
    s_xor_b32 s67, s60, 1
    s_mul_i32 s67, s67, 40960
    s_add_u32 s67, s67, s68
    v_add_u32 v94, s67, v66
    v_xor_b32 v95, 16, v94
    s_xor_b32 s67, s60, 2
    s_mul_i32 s67, s67, 40960
    s_add_u32 s67, s67, s68
    buffer_load_dwordx4 v50, s[48:51], s76 offen offset:2048 lds
    v_add_u32 v96, s67, v66
    v_xor_b32 v97, 16, v96
    s_xor_b32 s67, s60, 3
    s_mul_i32 s67, s67, 40960
    s_add_u32 s67, s67, s68
    v_add_u32 v98, s67, v66
    v_xor_b32 v99, 16, v98
    buffer_load_dwordx4 v51, s[48:51], s76 offen offset:3072 lds
    s_add_u32 s7, s7, 1
    s_cmp_eq_u32 s7, 7
    s_cselect_b32 s7, 0, s7
    s_mul_i32 s76, s7, 57344
    s_add_u32 m0, s20, 24576
    s_nop 0
    buffer_load_dwordx4 v48, s[48:51], s76 offen offset:0 lds
    buffer_load_dwordx4 v49, s[48:51], s76 offen offset:1024 lds
    buffer_load_dwordx4 v50, s[48:51], s76 offen offset:2048 lds
    buffer_load_dwordx4 v51, s[48:51], s76 offen offset:3072 lds
    s_add_u32 s76, s76, 28672
    s_add_u32 m0, s20, 28672
    s_nop 0
    buffer_load_dwordx4 v48, s[48:51], s76 offen offset:0 lds
    buffer_load_dwordx4 v49, s[48:51], s76 offen offset:1024 lds
    buffer_load_dwordx4 v50, s[48:51], s76 offen offset:2048 lds
    buffer_load_dwordx4 v51, s[48:51], s76 offen offset:3072 lds
    s_waitcnt vmcnt(14)
    v_cmp_ne_u64 vcc, s[56:57], v[46:47]
    s_cbranch_vccz Lok_4
    s_mov_b32 s78, 131072
Lspin_5:
    s_sleep 4
    buffer_load_dwordx2 v[46:47], v55, s[44:47], 0 offen sc1
    s_sub_u32 s78, s78, 1
    s_cbranch_scc1 Lok_4
    s_waitcnt vmcnt(0)
    v_cmp_ne_u64 vcc, s[56:57], v[46:47]
    s_cbranch_vccnz Lspin_5
Lok_4:
    s_waitcnt lgkmcnt(0)
    s_mov_b32 s3, s81
    s_lshl_b32 s79, s3, 12
    s_add_u32 s79, s79, s21
    buffer_load_dwordx4 a[96:99], v82, s[36:39], s79 offen offset:0 sc1
    buffer_load_dwordx4 a[100:103], v82, s[36:39], s79 offen offset:1024 sc1
    buffer_load_dwordx4 a[104:107], v82, s[36:39], s79 offen offset:2048 sc1
    buffer_load_dwordx4 a[108:111], v82, s[36:39], s79 offen offset:3072 sc1
    s_add_u32 s3, s3, 1
    s_cmp_eq_u32 s3, 7
    s_cselect_b32 s3, 0, s3
    s_lshl_b32 s79, s3, 12
    s_add_u32 s79, s79, s21
    buffer_load_dwordx4 a[112:115], v82, s[36:39], s79 offen offset:0 sc1
    buffer_load_dwordx4 a[116:119], v82, s[36:39], s79 offen offset:1024 sc1
    buffer_load_dwordx4 a[120:123], v82, s[36:39], s79 offen offset:2048 sc1
    buffer_load_dwordx4 a[124:127], v82, s[36:39], s79 offen offset:3072 sc1
    s_add_u32 s3, s3, 1
    s_cmp_eq_u32 s3, 7
    s_cselect_b32 s3, 0, s3
    s_lshl_b32 s79, s3, 12
    s_add_u32 s79, s79, s21
    buffer_load_dwordx4 a[128:131], v82, s[36:39], s79 offen offset:0 sc1
    buffer_load_dwordx4 a[132:135], v82, s[36:39], s79 offen offset:1024 sc1
    buffer_load_dwordx4 a[136:139], v82, s[36:39], s79 offen offset:2048 sc1
    buffer_load_dwordx4 a[140:143], v82, s[36:39], s79 offen offset:3072 sc1
    s_add_u32 s3, s3, 1
    s_cmp_eq_u32 s3, 7
    s_cselect_b32 s3, 0, s3
    s_lshl_b32 s79, s3, 12
    s_add_u32 s79, s79, s21
    buffer_load_dwordx4 a[144:147], v82, s[36:39], s79 offen offset:0 sc1
    buffer_load_dwordx4 a[148:151], v82, s[36:39], s79 offen offset:1024 sc1
    s_waitcnt vmcnt(13)
    v_mfma_f32_32x32x16_bf16 v[144:159], a[0:3], a[96:99], 0
    v_mfma_f32_32x32x16_bf16 v[160:175], a[4:7], a[96:99], 0
    s_movk_i32 s74, 0
    buffer_load_dwordx4 v[104:107], v45, s[40:43], s74 offen sc1
    s_waitcnt vmcnt(13)
    v_mfma_f32_32x32x16_bf16 v[144:159], a[8:11], a[100:103], v[144:159]
    v_mfma_f32_32x32x16_bf16 v[160:175], a[12:15], a[100:103], v[160:175]
    s_movk_i32 s74, 4096
    buffer_load_dwordx4 v[108:111], v45, s[40:43], s74 offen sc1
    s_waitcnt vmcnt(13)
    v_mfma_f32_32x32x16_bf16 v[144:159], a[16:19], a[104:107], v[144:159]
    v_mfma_f32_32x32x16_bf16 v[160:175], a[20:23], a[104:107], v[160:175]
    s_movk_i32 s74, 8192
    buffer_load_dwordx4 v[112:115], v45, s[40:43], s74 offen sc1
    s_waitcnt vmcnt(13)
    v_mfma_f32_32x32x16_bf16 v[144:159], a[24:27], a[108:111], v[144:159]
    v_mfma_f32_32x32x16_bf16 v[160:175], a[28:31], a[108:111], v[160:175]
    s_movk_i32 s74, 12288
    buffer_load_dwordx4 v[116:119], v45, s[40:43], s74 offen sc1
    s_lshl_b32 s74, s70, 9
    buffer_load_dword v36, v76, s[44:47], s74 offen offset:4 sc1
    buffer_load_dword v38, v42, s[44:47], s74 offen offset:4 sc1
    s_add_u32 s74, s74, 16384
    buffer_load_dword v37, v76, s[44:47], s74 offen offset:4 sc1
    buffer_load_dword v39, v42, s[44:47], s74 offen offset:4 sc1
    buffer_load_dwordx4 v[224:227], v74, s[24:27], 0 offen
    buffer_load_dwordx4 v[228:231], v75, s[24:27], 0 offen
    s_waitcnt vmcnt(19)
    v_mfma_f32_32x32x16_bf16 v[144:159], a[32:35], a[112:115], v[144:159]
    v_mfma_f32_32x32x16_bf16 v[160:175], a[36:39], a[112:115], v[160:175]
    buffer_load_dwordx4 a[152:155], v82, s[36:39], s79 offen offset:2048 sc1
    s_waitcnt vmcnt(19)
    v_mfma_f32_32x32x16_bf16 v[144:159], a[40:43], a[116:119], v[144:159]
    v_mfma_f32_32x32x16_bf16 v[160:175], a[44:47], a[116:119], v[160:175]
    buffer_load_dwordx4 a[156:159], v82, s[36:39], s79 offen offset:3072 sc1
    s_waitcnt vmcnt(19)
    v_mfma_f32_32x32x16_bf16 v[144:159], a[48:51], a[120:123], v[144:159]
    v_mfma_f32_32x32x16_bf16 v[160:175], a[52:55], a[120:123], v[160:175]
    s_add_u32 s3, s3, 1
    s_cmp_eq_u32 s3, 7
    s_cselect_b32 s3, 0, s3
    s_lshl_b32 s79, s3, 12
    s_add_u32 s79, s79, s21
    buffer_load_dwordx4 a[160:163], v82, s[36:39], s79 offen offset:0 sc1
    s_waitcnt vmcnt(19)
    v_mfma_f32_32x32x16_bf16 v[144:159], a[56:59], a[124:127], v[144:159]
    v_mfma_f32_32x32x16_bf16 v[160:175], a[60:63], a[124:127], v[160:175]
    buffer_load_dwordx4 a[164:167], v82, s[36:39], s79 offen offset:1024 sc1
    buffer_load_dwordx4 a[168:171], v82, s[36:39], s79 offen offset:2048 sc1
    s_waitcnt vmcnt(20)
    v_mfma_f32_32x32x16_bf16 v[144:159], a[64:67], a[128:131], v[144:159]
    v_mfma_f32_32x32x16_bf16 v[160:175], a[68:71], a[128:131], v[160:175]
    buffer_load_dwordx4 a[172:175], v82, s[36:39], s79 offen offset:3072 sc1
    s_waitcnt vmcnt(20)
    v_mfma_f32_32x32x16_bf16 v[144:159], a[72:75], a[132:135], v[144:159]
    ds_read_b64_tr_b16 a[224:225], v52 offset:0
    ds_read_b64_tr_b16 a[226:227], v52 offset:1024
    ds_read_b64_tr_b16 a[228:229], v53 offset:0
    ds_read_b64_tr_b16 a[230:231], v53 offset:1024
    v_mfma_f32_32x32x16_bf16 v[160:175], a[76:79], a[132:135], v[160:175]
    s_add_u32 s3, s3, 1
    s_cmp_eq_u32 s3, 7
    s_cselect_b32 s3, 0, s3
    s_lshl_b32 s79, s3, 12
    s_add_u32 s79, s79, s21
    buffer_load_dwordx4 a[176:179], v82, s[36:39], s79 offen offset:0 sc1
    s_waitcnt vmcnt(20)
    v_mfma_f32_32x32x16_bf16 v[144:159], a[80:83], a[136:139], v[144:159]
    ds_read_b64_tr_b16 a[232:233], v52 offset:2048
    ds_read_b64_tr_b16 a[234:235], v52 offset:3072
    ds_read_b64_tr_b16 a[236:237], v53 offset:2048
    ds_read_b64_tr_b16 a[238:239], v53 offset:3072
    v_mfma_f32_32x32x16_bf16 v[160:175], a[84:87], a[136:139], v[160:175]
    buffer_load_dwordx4 a[180:183], v82, s[36:39], s79 offen offset:1024 sc1
    s_waitcnt vmcnt(20)
    v_mfma_f32_32x32x16_bf16 v[144:159], a[88:91], a[140:143], v[144:159]
    ds_read_b64_tr_b16 a[240:241], v52 offset:4096
    ds_read_b64_tr_b16 a[242:243], v52 offset:5120
    ds_read_b64_tr_b16 a[244:245], v53 offset:4096
    ds_read_b64_tr_b16 a[246:247], v53 offset:5120
    v_mfma_f32_32x32x16_bf16 v[160:175], a[92:95], a[140:143], v[160:175]
    buffer_load_dwordx4 a[184:187], v82, s[36:39], s79 offen offset:2048 sc1
    buffer_load_dwordx4 a[188:191], v82, s[36:39], s79 offen offset:3072 sc1
    s_waitcnt vmcnt(21)
    s_waitcnt lgkmcnt(8)
    v_mfma_f32_32x32x16_bf16 v[144:159], a[224:227], a[144:147], v[144:159]
    ds_read_b64_tr_b16 a[248:249], v52 offset:6144
    ds_read_b64_tr_b16 a[250:251], v52 offset:7168
    ds_read_b64_tr_b16 a[252:253], v53 offset:6144
    ds_read_b64_tr_b16 a[254:255], v53 offset:7168
    v_mfma_f32_32x32x16_bf16 v[160:175], a[228:231], a[144:147], v[160:175]
    s_add_u32 s3, s3, 1
    s_cmp_eq_u32 s3, 7
    s_cselect_b32 s3, 0, s3
    s_lshl_b32 s79, s3, 12
    s_add_u32 s79, s79, s21
    buffer_load_dwordx4 a[192:195], v82, s[36:39], s79 offen offset:0 sc1
    s_waitcnt vmcnt(21)
    s_waitcnt lgkmcnt(8)
    v_mfma_f32_32x32x16_bf16 v[144:159], a[232:235], a[148:151], v[144:159]
    ds_read_b64_tr_b16 a[224:225], v52 offset:8192
    ds_read_b64_tr_b16 a[226:227], v52 offset:9216
    ds_read_b64_tr_b16 a[228:229], v53 offset:8192
    ds_read_b64_tr_b16 a[230:231], v53 offset:9216
    v_mfma_f32_32x32x16_bf16 v[160:175], a[236:239], a[148:151], v[160:175]
    buffer_load_dwordx4 a[196:199], v82, s[36:39], s79 offen offset:1024 sc1
    s_waitcnt vmcnt(11)
    s_waitcnt lgkmcnt(8)
    v_mfma_f32_32x32x16_bf16 v[144:159], a[240:243], a[152:155], v[144:159]
    ds_read_b64_tr_b16 a[232:233], v52 offset:10240
    ds_read_b64_tr_b16 a[234:235], v52 offset:11264
    ds_read_b64_tr_b16 a[236:237], v53 offset:10240
    ds_read_b64_tr_b16 a[238:239], v53 offset:11264
    v_mfma_f32_32x32x16_bf16 v[160:175], a[244:247], a[152:155], v[160:175]
    buffer_load_dwordx4 a[200:203], v82, s[36:39], s79 offen offset:2048 sc1
    s_waitcnt vmcnt(11)
    s_waitcnt lgkmcnt(8)
    v_mfma_f32_32x32x16_bf16 v[144:159], a[248:251], a[156:159], v[144:159]
    ds_read_b64_tr_b16 a[240:241], v52 offset:12288
    ds_read_b64_tr_b16 a[242:243], v52 offset:13312
    ds_read_b64_tr_b16 a[244:245], v53 offset:12288
    ds_read_b64_tr_b16 a[246:247], v53 offset:13312
    v_mfma_f32_32x32x16_bf16 v[160:175], a[252:255], a[156:159], v[160:175]
    buffer_load_dwordx4 a[204:207], v82, s[36:39], s79 offen offset:3072 sc1
    s_mov_b32 s6, s81
    s_lshl_b32 s80, s6, 12
    s_add_u32 s80, s80, s21
    s_add_u32 s80, s80, 3801088
    buffer_load_dwordx4 a[208:211], v82, s[36:39], s80 offen offset:0 sc1
    s_waitcnt vmcnt(12)
    s_waitcnt lgkmcnt(8)
    v_mfma_f32_32x32x16_bf16 v[144:159], a[224:227], a[160:163], v[144:159]
    ds_read_b64_tr_b16 a[248:249], v52 offset:14336
    ds_read_b64_tr_b16 a[250:251], v52 offset:15360
    ds_read_b64_tr_b16 a[252:253], v53 offset:14336
    ds_read_b64_tr_b16 a[254:255], v53 offset:15360
    v_mfma_f32_32x32x16_bf16 v[160:175], a[228:231], a[160:163], v[160:175]
    buffer_load_dwordx4 a[212:215], v82, s[36:39], s80 offen offset:1024 sc1
    s_waitcnt vmcnt(12)
    s_waitcnt lgkmcnt(8)
    v_mfma_f32_32x32x16_bf16 v[144:159], a[232:235], a[164:167], v[144:159]
    ds_read_b64_tr_b16 a[224:225], v52 offset:16384
    ds_read_b64_tr_b16 a[226:227], v52 offset:17408
    ds_read_b64_tr_b16 a[228:229], v53 offset:16384
    ds_read_b64_tr_b16 a[230:231], v53 offset:17408
    v_mfma_f32_32x32x16_bf16 v[160:175], a[236:239], a[164:167], v[160:175]
    buffer_load_dwordx4 a[216:219], v82, s[36:39], s80 offen offset:2048 sc1
    s_waitcnt vmcnt(12)
    s_waitcnt lgkmcnt(8)
    v_mfma_f32_32x32x16_bf16 v[144:159], a[240:243], a[168:171], v[144:159]
    ds_read_b64_tr_b16 a[232:233], v52 offset:18432
    ds_read_b64_tr_b16 a[234:235], v52 offset:19456
    ds_read_b64_tr_b16 a[236:237], v53 offset:18432
    ds_read_b64_tr_b16 a[238:239], v53 offset:19456
    v_mfma_f32_32x32x16_bf16 v[160:175], a[244:247], a[168:171], v[160:175]
    buffer_load_dwordx4 a[220:223], v82, s[36:39], s80 offen offset:3072 sc1
    s_waitcnt vmcnt(12)
    s_waitcnt lgkmcnt(8)
    v_mfma_f32_32x32x16_bf16 v[144:159], a[248:251], a[172:175], v[144:159]
    ds_read_b64_tr_b16 a[240:241], v52 offset:20480
    ds_read_b64_tr_b16 a[242:243], v52 offset:21504
    ds_read_b64_tr_b16 a[244:245], v53 offset:20480
    ds_read_b64_tr_b16 a[246:247], v53 offset:21504
    v_mfma_f32_32x32x16_bf16 v[160:175], a[252:255], a[172:175], v[160:175]
    s_add_u32 s6, s6, 1
    s_cmp_eq_u32 s6, 7
    s_cselect_b32 s6, 0, s6
    s_lshl_b32 s80, s6, 12
    s_add_u32 s80, s80, s21
    s_add_u32 s80, s80, 3801088
    buffer_load_dwordx4 a[96:99], v82, s[36:39], s80 offen offset:0 sc1
    buffer_load_dwordx4 a[100:103], v82, s[36:39], s80 offen offset:1024 sc1
    s_waitcnt vmcnt(13)
    s_waitcnt lgkmcnt(8)
    v_mfma_f32_32x32x16_bf16 v[144:159], a[224:227], a[176:179], v[144:159]
    ds_read_b64_tr_b16 a[248:249], v52 offset:22528
    ds_read_b64_tr_b16 a[250:251], v52 offset:23552
    ds_read_b64_tr_b16 a[252:253], v53 offset:22528
    ds_read_b64_tr_b16 a[254:255], v53 offset:23552
    v_mfma_f32_32x32x16_bf16 v[160:175], a[228:231], a[176:179], v[160:175]
    buffer_load_dwordx4 a[104:107], v82, s[36:39], s80 offen offset:2048 sc1
    v_xor_b32 v104, v104, v72
    v_xor_b32 v105, v105, v72
    v_xor_b32 v106, v106, v72
    v_xor_b32 v107, v107, v72
    s_nop 1
    v_mfma_f32_32x32x16_bf16 v[208:223], v[104:107], v[4:7], 0
    s_waitcnt vmcnt(13)
    s_waitcnt lgkmcnt(8)
    v_mfma_f32_32x32x16_bf16 v[144:159], a[232:235], a[180:183], v[144:159]
    ds_read_b64_tr_b16 a[224:225], v52 offset:24576
    ds_read_b64_tr_b16 a[226:227], v52 offset:25600
    ds_read_b64_tr_b16 a[228:229], v53 offset:24576
    ds_read_b64_tr_b16 a[230:231], v53 offset:25600
    v_mfma_f32_32x32x16_bf16 v[160:175], a[236:239], a[180:183], v[160:175]
    buffer_load_dwordx4 a[108:111], v82, s[36:39], s80 offen offset:3072 sc1
    v_mfma_f32_32x32x16_bf16 v[240:255], v[104:107], v[20:23], 0
    s_waitcnt vmcnt(13)
    s_waitcnt lgkmcnt(8)
    v_mfma_f32_32x32x16_bf16 v[144:159], a[240:243], a[184:187], v[144:159]
    ds_read_b64_tr_b16 a[232:233], v52 offset:26624
    ds_read_b64_tr_b16 a[234:235], v52 offset:27648
    ds_read_b64_tr_b16 a[236:237], v53 offset:26624
    ds_read_b64_tr_b16 a[238:239], v53 offset:27648
    v_mfma_f32_32x32x16_bf16 v[160:175], a[244:247], a[184:187], v[160:175]
    s_add_u32 s6, s6, 1
    s_cmp_eq_u32 s6, 7
    s_cselect_b32 s6, 0, s6
    s_lshl_b32 s80, s6, 12
    s_add_u32 s80, s80, s21
    s_add_u32 s80, s80, 3801088
    buffer_load_dwordx4 a[112:115], v82, s[36:39], s80 offen offset:0 sc1
    v_xor_b32 v108, v108, v72
    v_xor_b32 v109, v109, v72
    v_xor_b32 v110, v110, v72
    v_xor_b32 v111, v111, v72
    s_nop 1
    v_mfma_f32_32x32x16_bf16 v[208:223], v[108:111], v[8:11], v[208:223]
    s_waitcnt vmcnt(13)
    s_waitcnt lgkmcnt(8)
    v_mfma_f32_32x32x16_bf16 v[144:159], a[248:251], a[188:191], v[144:159]
    ds_read_b64_tr_b16 a[240:241], v52 offset:28672
    ds_read_b64_tr_b16 a[242:243], v52 offset:29696
    ds_read_b64_tr_b16 a[244:245], v53 offset:28672
    ds_read_b64_tr_b16 a[246:247], v53 offset:29696
    v_mfma_f32_32x32x16_bf16 v[160:175], a[252:255], a[188:191], v[160:175]
    buffer_load_dwordx4 a[116:119], v82, s[36:39], s80 offen offset:1024 sc1
    buffer_load_dwordx4 a[120:123], v82, s[36:39], s80 offen offset:2048 sc1
    v_mfma_f32_32x32x16_bf16 v[240:255], v[108:111], v[24:27], v[240:255]
    s_waitcnt vmcnt(14)
    s_waitcnt lgkmcnt(8)
    v_mfma_f32_32x32x16_bf16 v[144:159], a[224:227], a[192:195], v[144:159]
    ds_read_b64_tr_b16 a[248:249], v52 offset:30720
    ds_read_b64_tr_b16 a[250:251], v52 offset:31744
    ds_read_b64_tr_b16 a[252:253], v53 offset:30720
    ds_read_b64_tr_b16 a[254:255], v53 offset:31744
    v_mfma_f32_32x32x16_bf16 v[160:175], a[228:231], a[192:195], v[160:175]
    buffer_load_dwordx4 a[124:127], v82, s[36:39], s80 offen offset:3072 sc1
    v_xor_b32 v112, v112, v72
    v_xor_b32 v113, v113, v72
    v_xor_b32 v114, v114, v72
    v_xor_b32 v115, v115, v72
    s_nop 1
    v_mfma_f32_32x32x16_bf16 v[208:223], v[112:115], v[12:15], v[208:223]
    s_waitcnt vmcnt(14)
    s_waitcnt lgkmcnt(8)
    v_mfma_f32_32x32x16_bf16 v[144:159], a[232:235], a[196:199], v[144:159]
    v_mfma_f32_32x32x16_bf16 v[160:175], a[236:239], a[196:199], v[160:175]
    s_add_u32 s6, s6, 1
    s_cmp_eq_u32 s6, 7
    s_cselect_b32 s6, 0, s6
    s_lshl_b32 s80, s6, 12
    s_add_u32 s80, s80, s21
    s_add_u32 s80, s80, 3801088
    buffer_load_dwordx4 a[128:131], v82, s[36:39], s80 offen offset:0 sc1
    v_mfma_f32_32x32x16_bf16 v[240:255], v[112:115], v[28:31], v[240:255]
    s_waitcnt vmcnt(14)
    s_waitcnt lgkmcnt(4)
    v_mfma_f32_32x32x16_bf16 v[144:159], a[240:243], a[200:203], v[144:159]
    v_mfma_f32_32x32x16_bf16 v[160:175], a[244:247], a[200:203], v[160:175]
    buffer_load_dwordx4 a[132:135], v82, s[36:39], s80 offen offset:1024 sc1
    v_xor_b32 v116, v116, v72
    v_xor_b32 v117, v117, v72
    v_xor_b32 v118, v118, v72
    v_xor_b32 v119, v119, v72
    s_nop 1
    v_mfma_f32_32x32x16_bf16 v[208:223], v[116:119], v[16:19], v[208:223]
    s_waitcnt vmcnt(14)
    s_waitcnt lgkmcnt(0)
    v_mfma_f32_32x32x16_bf16 v[144:159], a[248:251], a[204:207], v[144:159]
    v_mfma_f32_32x32x16_bf16 v[160:175], a[252:255], a[204:207], v[160:175]
    buffer_load_dwordx4 a[136:139], v82, s[36:39], s80 offen offset:2048 sc1
    buffer_load_dwordx4 a[140:143], v82, s[36:39], s80 offen offset:3072 sc1
    v_mfma_f32_32x32x16_bf16 v[240:255], v[116:119], v[32:35], v[240:255]
    v_rcp_f32 v38, v38
    v_rcp_f32 v39, v39
    s_waitcnt vmcnt(15)
    v_mfma_f32_32x32x16_bf16 v[176:191], a[0:3], a[208:211], 0
    v_mfma_f32_32x32x16_bf16 v[192:207], a[4:7], a[208:211], 0
    s_add_u32 s6, s6, 1
    s_cmp_eq_u32 s6, 7
    s_cselect_b32 s6, 0, s6
    s_lshl_b32 s80, s6, 12
    s_add_u32 s80, s80, s21
    s_add_u32 s80, s80, 3801088
    buffer_load_dwordx4 a[144:147], v82, s[36:39], s80 offen offset:0 sc1
    s_waitcnt vmcnt(15)
    v_mfma_f32_32x32x16_bf16 v[176:191], a[8:11], a[212:215], v[176:191]
    v_mfma_f32_32x32x16_bf16 v[192:207], a[12:15], a[212:215], v[192:207]
    buffer_load_dwordx4 a[148:151], v82, s[36:39], s80 offen offset:1024 sc1
    s_waitcnt vmcnt(15)
    v_mfma_f32_32x32x16_bf16 v[176:191], a[16:19], a[216:219], v[176:191]
    v_mfma_f32_32x32x16_bf16 v[192:207], a[20:23], a[216:219], v[192:207]
    buffer_load_dwordx4 a[152:155], v82, s[36:39], s80 offen offset:2048 sc1
    s_waitcnt vmcnt(15)
    v_mfma_f32_32x32x16_bf16 v[176:191], a[24:27], a[220:223], v[176:191]
    ds_write_b128 v88, v[160:163]
    ds_write_b128 v89, v[164:167]
    v_mfma_f32_32x32x16_bf16 v[192:207], a[28:31], a[220:223], v[192:207]
    buffer_load_dwordx4 a[156:159], v82, s[36:39], s80 offen offset:3072 sc1
    s_add_u32 s6, s6, 1
    s_cmp_eq_u32 s6, 7
    s_cselect_b32 s6, 0, s6
    s_lshl_b32 s80, s6, 12
    s_add_u32 s80, s80, s21
    s_add_u32 s80, s80, 3801088
    buffer_load_dwordx4 a[160:163], v82, s[36:39], s80 offen offset:0 sc1
    ds_write_b128 v90, v[168:171]
    ds_write_b128 v91, v[172:175]
    v_fmac_f32 v144, v208, v38
    s_waitcnt vmcnt(16)
    v_mfma_f32_32x32x16_bf16 v[176:191], a[32:35], a[96:99], v[176:191]
    v_fmac_f32 v145, v209, v38
    v_fmac_f32 v146, v210, v38
    v_mfma_f32_32x32x16_bf16 v[192:207], a[36:39], a[96:99], v[192:207]
    buffer_load_dwordx4 a[164:167], v82, s[36:39], s80 offen offset:1024 sc1
    v_fmac_f32 v147, v211, v38
    v_fmac_f32 v148, v212, v38
    v_fmac_f32 v149, v213, v38
    s_waitcnt vmcnt(16)
    v_mfma_f32_32x32x16_bf16 v[176:191], a[40:43], a[100:103], v[176:191]
    v_fmac_f32 v150, v214, v38
    v_fmac_f32 v151, v215, v38
    v_mfma_f32_32x32x16_bf16 v[192:207], a[44:47], a[100:103], v[192:207]
    buffer_load_dwordx4 a[168:171], v82, s[36:39], s80 offen offset:2048 sc1
    v_fmac_f32 v152, v216, v38
    v_fmac_f32 v153, v217, v38
    v_fmac_f32 v154, v218, v38
    s_waitcnt vmcnt(16)
    v_mfma_f32_32x32x16_bf16 v[176:191], a[48:51], a[104:107], v[176:191]
    v_fmac_f32 v155, v219, v38
    v_fmac_f32 v156, v220, v38
    v_mfma_f32_32x32x16_bf16 v[192:207], a[52:55], a[104:107], v[192:207]
    buffer_load_dwordx4 a[172:175], v82, s[36:39], s80 offen offset:3072 sc1
    v_fmac_f32 v157, v221, v38
    v_fmac_f32 v158, v222, v38
    v_fmac_f32 v159, v223, v38
    s_waitcnt vmcnt(16)
    v_mfma_f32_32x32x16_bf16 v[176:191], a[56:59], a[108:111], v[176:191]
    ds_write_b128 v84, v[144:147]
    ds_write_b128 v85, v[148:151]
    v_mfma_f32_32x32x16_bf16 v[192:207], a[60:63], a[108:111], v[192:207]
    s_add_u32 s6, s6, 1
    s_cmp_eq_u32 s6, 7
    s_cselect_b32 s6, 0, s6
    s_lshl_b32 s80, s6, 12
    s_add_u32 s80, s80, s21
    s_add_u32 s80, s80, 3801088
    buffer_load_dwordx4 a[176:179], v82, s[36:39], s80 offen offset:0 sc1
    buffer_load_dwordx4 a[180:183], v82, s[36:39], s80 offen offset:1024 sc1
    ds_write_b128 v86, v[152:155]
    ds_write_b128 v87, v[156:159]
    s_waitcnt vmcnt(17)
    v_mfma_f32_32x32x16_bf16 v[176:191], a[64:67], a[112:115], v[176:191]
    v_mfma_f32_32x32x16_bf16 v[192:207], a[68:71], a[112:115], v[192:207]
    buffer_load_dwordx4 a[184:187], v82, s[36:39], s80 offen offset:2048 sc1
    s_waitcnt vmcnt(17)
    v_mfma_f32_32x32x16_bf16 v[176:191], a[72:75], a[116:119], v[176:191]
    ds_read_b64_tr_b16 a[224:225], v52 offset:0
    ds_read_b64_tr_b16 a[226:227], v52 offset:1024
    ds_read_b64_tr_b16 a[228:229], v53 offset:0
    ds_read_b64_tr_b16 a[230:231], v53 offset:1024
    v_mfma_f32_32x32x16_bf16 v[192:207], a[76:79], a[116:119], v[192:207]
    buffer_load_dwordx4 a[188:191], v82, s[36:39], s80 offen offset:3072 sc1
    s_waitcnt vmcnt(17)
    v_mfma_f32_32x32x16_bf16 v[176:191], a[80:83], a[120:123], v[176:191]
    ds_read_b64_tr_b16 a[232:233], v52 offset:2048
    ds_read_b64_tr_b16 a[234:235], v52 offset:3072
    ds_read_b64_tr_b16 a[236:237], v53 offset:2048
    ds_read_b64_tr_b16 a[238:239], v53 offset:3072
    v_mfma_f32_32x32x16_bf16 v[192:207], a[84:87], a[120:123], v[192:207]
    s_waitcnt lgkmcnt(8)
    s_barrier
    s_waitcnt vmcnt(16)
    v_mfma_f32_32x32x16_bf16 v[176:191], a[88:91], a[124:127], v[176:191]
    ds_read_b64_tr_b16 a[240:241], v52 offset:4096
    ds_read_b64_tr_b16 a[242:243], v52 offset:5120
    ds_read_b64_tr_b16 a[244:245], v53 offset:4096
    ds_read_b64_tr_b16 a[246:247], v53 offset:5120
    ds_read_b128 v[104:107], v92
    v_mfma_f32_32x32x16_bf16 v[192:207], a[92:95], a[124:127], v[192:207]
    ds_read_b128 v[108:111], v93
    ds_read_b128 v[112:115], v94
    ds_read_b128 v[116:119], v95
    ds_read_b128 v[120:123], v96
    ds_read_b128 v[124:127], v97
    s_waitcnt vmcnt(15)
    s_waitcnt lgkmcnt(14)
    v_mfma_f32_32x32x16_bf16 v[176:191], a[224:227], a[128:131], v[176:191]
    ds_read_b64_tr_b16 a[248:249], v52 offset:6144
    ds_read_b64_tr_b16 a[250:251], v52 offset:7168
    ds_read_b64_tr_b16 a[252:253], v53 offset:6144
    ds_read_b64_tr_b16 a[254:255], v53 offset:7168
    ds_read_b128 v[128:131], v98
    v_mfma_f32_32x32x16_bf16 v[192:207], a[228:231], a[128:131], v[192:207]
    ds_read_b128 v[132:135], v99
    v_lshlrev_b32 v56, 16, v224
    v_and_b32 v57, 0xffff0000, v224
    v_lshlrev_b32 v58, 16, v225
    v_and_b32 v59, 0xffff0000, v225
    s_waitcnt vmcnt(14)
    s_waitcnt lgkmcnt(15)
    v_mfma_f32_32x32x16_bf16 v[176:191], a[232:235], a[132:135], v[176:191]
    ds_read_b64_tr_b16 a[224:225], v52 offset:8192
    ds_read_b64_tr_b16 a[226:227], v52 offset:9216
    ds_read_b64_tr_b16 a[228:229], v53 offset:8192
    ds_read_b64_tr_b16 a[230:231], v53 offset:9216
    v_lshlrev_b32 v60, 16, v226
    v_mfma_f32_32x32x16_bf16 v[192:207], a[236:239], a[132:135], v[192:207]
    v_and_b32 v61, 0xffff0000, v226
    v_lshlrev_b32 v62, 16, v227
    v_and_b32 v63, 0xffff0000, v227
    s_waitcnt lgkmcnt(12)
    v_add_f32 v104, v104, v112
    s_waitcnt vmcnt(13)
    v_mfma_f32_32x32x16_bf16 v[176:191], a[240:243], a[136:139], v[176:191]
    ds_read_b64_tr_b16 a[232:233], v52 offset:10240
    ds_read_b64_tr_b16 a[234:235], v52 offset:11264
    ds_read_b64_tr_b16 a[236:237], v53 offset:10240
    ds_read_b64_tr_b16 a[238:239], v53 offset:11264
    v_add_f32 v105, v105, v113
    v_mfma_f32_32x32x16_bf16 v[192:207], a[244:247], a[136:139], v[192:207]
    v_add_f32 v106, v106, v114
    v_add_f32 v107, v107, v115
    v_add_f32 v108, v108, v116
    v_add_f32 v109, v109, v117
    v_add_f32 v110, v110, v118
    s_waitcnt vmcnt(12)
    s_waitcnt lgkmcnt(10)
    v_mfma_f32_32x32x16_bf16 v[176:191], a[248:251], a[140:143], v[176:191]
    ds_read_b64_tr_b16 a[240:241], v52 offset:12288
    ds_read_b64_tr_b16 a[242:243], v52 offset:13312
    ds_read_b64_tr_b16 a[244:245], v53 offset:12288
    ds_read_b64_tr_b16 a[246:247], v53 offset:13312
    v_add_f32 v111, v111, v119
    v_mfma_f32_32x32x16_bf16 v[192:207], a[252:255], a[140:143], v[192:207]
    s_waitcnt lgkmcnt(12)
    v_add_f32 v120, v120, v128
    v_add_f32 v121, v121, v129
    v_add_f32 v122, v122, v130
    v_add_f32 v123, v123, v131
    s_waitcnt vmcnt(11)
    s_waitcnt lgkmcnt(8)
    v_mfma_f32_32x32x16_bf16 v[176:191], a[224:227], a[144:147], v[176:191]
    ds_read_b64_tr_b16 a[248:249], v52 offset:14336
    ds_read_b64_tr_b16 a[250:251], v52 offset:15360
    ds_read_b64_tr_b16 a[252:253], v53 offset:14336
    ds_read_b64_tr_b16 a[254:255], v53 offset:15360
    v_add_f32 v124, v124, v132
    v_mfma_f32_32x32x16_bf16 v[192:207], a[228:231], a[144:147], v[192:207]
    v_add_f32 v125, v125, v133
    v_add_f32 v126, v126, v134
    v_add_f32 v127, v127, v135
    v_add_f32 v104, v104, v120
    v_add_f32 v105, v105, v121
    s_waitcnt vmcnt(10)
    s_waitcnt lgkmcnt(8)
    v_mfma_f32_32x32x16_bf16 v[176:191], a[232:235], a[148:151], v[176:191]
    ds_read_b64_tr_b16 a[224:225], v52 offset:16384
    ds_read_b64_tr_b16 a[226:227], v52 offset:17408
    ds_read_b64_tr_b16 a[228:229], v53 offset:16384
    ds_read_b64_tr_b16 a[230:231], v53 offset:17408
    v_add_f32 v106, v106, v122
    v_mfma_f32_32x32x16_bf16 v[192:207], a[236:239], a[148:151], v[192:207]
    v_add_f32 v107, v107, v123
    v_add_f32 v108, v108, v124
    v_add_f32 v109, v109, v125
    v_add_f32 v110, v110, v126
    v_add_f32 v111, v111, v127
    s_waitcnt vmcnt(9)
    s_waitcnt lgkmcnt(8)
    v_mfma_f32_32x32x16_bf16 v[176:191], a[240:243], a[152:155], v[176:191]
    ds_read_b64_tr_b16 a[232:233], v52 offset:18432
    ds_read_b64_tr_b16 a[234:235], v52 offset:19456
    ds_read_b64_tr_b16 a[236:237], v53 offset:18432
    ds_read_b64_tr_b16 a[238:239], v53 offset:19456
    v_fma_f32 v104, v104, v36, v56
    v_mfma_f32_32x32x16_bf16 v[192:207], a[244:247], a[152:155], v[192:207]
    v_fma_f32 v105, v105, v36, v57
    v_fma_f32 v106, v106, v36, v58
    v_fma_f32 v107, v107, v36, v59
    v_fma_f32 v108, v108, v36, v60
    v_fma_f32 v109, v109, v36, v61
    s_waitcnt vmcnt(8)
    s_waitcnt lgkmcnt(8)
    v_mfma_f32_32x32x16_bf16 v[176:191], a[248:251], a[156:159], v[176:191]
    ds_read_b64_tr_b16 a[240:241], v52 offset:20480
    ds_read_b64_tr_b16 a[242:243], v52 offset:21504
    ds_read_b64_tr_b16 a[244:245], v53 offset:20480
    ds_read_b64_tr_b16 a[246:247], v53 offset:21504
    v_fma_f32 v110, v110, v36, v62
    v_mfma_f32_32x32x16_bf16 v[192:207], a[252:255], a[156:159], v[192:207]
    v_fma_f32 v111, v111, v36, v63
    v_cvt_pk_bf16_f32 v56, v104, v105
    v_cvt_pk_bf16_f32 v57, v106, v107
    v_cvt_pk_bf16_f32 v58, v108, v109
    v_cvt_pk_bf16_f32 v59, v110, v111
    s_waitcnt vmcnt(7)
    s_waitcnt lgkmcnt(8)
    v_mfma_f32_32x32x16_bf16 v[176:191], a[224:227], a[160:163], v[176:191]
    ds_read_b64_tr_b16 a[248:249], v52 offset:22528
    ds_read_b64_tr_b16 a[250:251], v52 offset:23552
    ds_read_b64_tr_b16 a[252:253], v53 offset:22528
    ds_read_b64_tr_b16 a[254:255], v53 offset:23552
    buffer_store_dwordx4 v[56:59], v74, s[52:55], 0 offen
    v_mfma_f32_32x32x16_bf16 v[192:207], a[228:231], a[160:163], v[192:207]
    s_waitcnt vmcnt(7)
    s_waitcnt lgkmcnt(8)
    v_mfma_f32_32x32x16_bf16 v[176:191], a[232:235], a[164:167], v[176:191]
    ds_read_b64_tr_b16 a[224:225], v52 offset:24576
    ds_read_b64_tr_b16 a[226:227], v52 offset:25600
    ds_read_b64_tr_b16 a[228:229], v53 offset:24576
    ds_read_b64_tr_b16 a[230:231], v53 offset:25600
    v_mfma_f32_32x32x16_bf16 v[192:207], a[236:239], a[164:167], v[192:207]
    s_waitcnt vmcnt(6)
    s_waitcnt lgkmcnt(8)
    v_mfma_f32_32x32x16_bf16 v[176:191], a[240:243], a[168:171], v[176:191]
    ds_read_b64_tr_b16 a[232:233], v52 offset:26624
    ds_read_b64_tr_b16 a[234:235], v52 offset:27648
    ds_read_b64_tr_b16 a[236:237], v53 offset:26624
    ds_read_b64_tr_b16 a[238:239], v53 offset:27648
    v_mfma_f32_32x32x16_bf16 v[192:207], a[244:247], a[168:171], v[192:207]
    s_waitcnt vmcnt(5)
    s_waitcnt lgkmcnt(8)
    v_mfma_f32_32x32x16_bf16 v[176:191], a[248:251], a[172:175], v[176:191]
    ds_read_b64_tr_b16 a[240:241], v52 offset:28672
    ds_read_b64_tr_b16 a[242:243], v52 offset:29696
    ds_read_b64_tr_b16 a[244:245], v53 offset:28672
    ds_read_b64_tr_b16 a[246:247], v53 offset:29696
    v_mfma_f32_32x32x16_bf16 v[192:207], a[252:255], a[172:175], v[192:207]
    s_waitcnt vmcnt(4)
    s_waitcnt lgkmcnt(8)
    v_mfma_f32_32x32x16_bf16 v[176:191], a[224:227], a[176:179], v[176:191]
    ds_read_b64_tr_b16 a[248:249], v52 offset:30720
    ds_read_b64_tr_b16 a[250:251], v52 offset:31744
    ds_read_b64_tr_b16 a[252:253], v53 offset:30720
    ds_read_b64_tr_b16 a[254:255], v53 offset:31744
    v_mfma_f32_32x32x16_bf16 v[192:207], a[228:231], a[176:179], v[192:207]
    s_waitcnt vmcnt(3)
    s_waitcnt lgkmcnt(8)
    v_mfma_f32_32x32x16_bf16 v[176:191], a[232:235], a[180:183], v[176:191]
    v_mfma_f32_32x32x16_bf16 v[192:207], a[236:239], a[180:183], v[192:207]
    s_barrier
    s_waitcnt vmcnt(2)
    s_waitcnt lgkmcnt(4)
    v_mfma_f32_32x32x16_bf16 v[176:191], a[240:243], a[184:187], v[176:191]
    v_mfma_f32_32x32x16_bf16 v[192:207], a[244:247], a[184:187], v[192:207]
    s_waitcnt vmcnt(1)
    s_waitcnt lgkmcnt(0)
    v_mfma_f32_32x32x16_bf16 v[176:191], a[248:251], a[188:191], v[176:191]
    v_mfma_f32_32x32x16_bf16 v[192:207], a[252:255], a[188:191], v[192:207]
    s_nop 10
    v_fmac_f32 v176, v240, v39
    v_fmac_f32 v177, v241, v39
    v_fmac_f32 v178, v242, v39
    v_fmac_f32 v179, v243, v39
    v_fmac_f32 v180, v244, v39
    v_fmac_f32 v181, v245, v39
    v_fmac_f32 v182, v246, v39
    v_fmac_f32 v183, v247, v39
    v_fmac_f32 v184, v248, v39
    v_fmac_f32 v185, v249, v39
    v_fmac_f32 v186, v250, v39
    v_fmac_f32 v187, v251, v39
    v_fmac_f32 v188, v252, v39
    v_fmac_f32 v189, v253, v39
    v_fmac_f32 v190, v254, v39
    v_fmac_f32 v191, v255, v39
    ds_write_b128 v84, v[176:179]
    ds_write_b128 v85, v[180:183]
    ds_write_b128 v86, v[184:187]
    ds_write_b128 v87, v[188:191]
    ds_write_b128 v88, v[192:195]
    ds_write_b128 v89, v[196:199]
    ds_write_b128 v90, v[200:203]
    ds_write_b128 v91, v[204:207]
    s_waitcnt lgkmcnt(0)
    s_barrier
    ds_read_b128 v[104:107], v92
    ds_read_b128 v[108:111], v93
    ds_read_b128 v[112:115], v94
    ds_read_b128 v[116:119], v95
    ds_read_b128 v[120:123], v96
    ds_read_b128 v[124:127], v97
    ds_read_b128 v[128:131], v98
    ds_read_b128 v[132:135], v99
    v_lshlrev_b32 v56, 16, v228
    v_and_b32 v57, 0xffff0000, v228
    v_lshlrev_b32 v58, 16, v229
    v_and_b32 v59, 0xffff0000, v229
    v_lshlrev_b32 v60, 16, v230
    v_and_b32 v61, 0xffff0000, v230
    v_lshlrev_b32 v62, 16, v231
    v_and_b32 v63, 0xffff0000, v231
    s_waitcnt lgkmcnt(4)
    v_add_f32 v104, v104, v112
    v_add_f32 v105, v105, v113
    v_add_f32 v106, v106, v114
    v_add_f32 v107, v107, v115
    v_add_f32 v108, v108, v116
    v_add_f32 v109, v109, v117
    v_add_f32 v110, v110, v118
    v_add_f32 v111, v111, v119
    s_waitcnt lgkmcnt(0)
    v_add_f32 v120, v120, v128
    v_add_f32 v121, v121, v129
    v_add_f32 v122, v122, v130
    v_add_f32 v123, v123, v131
    v_add_f32 v124, v124, v132
    v_add_f32 v125, v125, v133
    v_add_f32 v126, v126, v134
    v_add_f32 v127, v127, v135
    v_add_f32 v104, v104, v120
    v_add_f32 v105, v105, v121
    v_add_f32 v106, v106, v122
    v_add_f32 v107, v107, v123
    v_add_f32 v108, v108, v124
    v_add_f32 v109, v109, v125
    v_add_f32 v110, v110, v126
    v_add_f32 v111, v111, v127
    v_fma_f32 v104, v104, v37, v56
    v_fma_f32 v105, v105, v37, v57
    v_fma_f32 v106, v106, v37, v58
    v_fma_f32 v107, v107, v37, v59
    v_fma_f32 v108, v108, v37, v60
    v_fma_f32 v109, v109, v37, v61
    v_fma_f32 v110, v110, v37, v62
    v_fma_f32 v111, v111, v37, v63
    v_cvt_pk_bf16_f32 v56, v104, v105
    v_cvt_pk_bf16_f32 v57, v106, v107
    v_cvt_pk_bf16_f32 v58, v108, v109
    v_cvt_pk_bf16_f32 v59, v110, v111
    buffer_store_dwordx4 v[56:59], v75, s[52:55], 0 offen
    s_branch Lfin
LroleBC:
    s_cmp_ge_u32 s76, 30
    s_cbranch_scc1 LroleC
    s_lshl_b32 s61, s67, 2
    s_lshl_b32 s68, s68, 1
    s_add_u32 s61, s61, s68
    s_add_u32 s61, s61, s76
    s_sub_u32 s61, s61, 28
    s_mov_b32 s62, s61
    s_lshl_b32 s63, s61, 1
    s_add_u32 s63, s63, s60
    s_lshl_b32 s67, s59, 5
    s_add_u32 s63, s63, s67
    v_lshrrev_b32 v105, 3, v1
    v_and_b32 v106, 7, v1
    v_lshrrev_b32 v107, 1, v105
    v_xor_b32 v108, v106, v107
    v_lshlrev_b32 v108, 4, v108
    v_mul_u32_u24 v109, 57344, v105
    s_mul_i32 s67, s63, 896
    v_add3_u32 v4, v109, v108, s67
    v_xor_b32 v5, 64, v4
    v_add_u32 v6, 915456, v4
    v_add_u32 v7, 1373184, v5
    v_add_u32 v5, 457728, v5
    v_and_b32 v110, 1, v107
    v_lshlrev_b32 v110, 2, v110
    v_xor_b32 v110, v110, v106
    v_lshlrev_b32 v110, 4, v110
    v_mul_u32_u24 v111, 3584, v105
    s_mul_i32 s67, s59, 114688
    s_lshl_b32 s68, s62, 8
    s_add_u32 s67, s67, s68
    s_lshl_b32 s68, s60, 7
    s_add_u32 s67, s67, s68
    v_add3_u32 v8, v111, v110, s67
    v_add_u32 v9, 27648, v8
    v_add_u32 v10, 55296, v8
    v_add_u32 v11, 82944, v8
    v_mul_u32_u24 v109, 896, v105
    s_lshl_b32 s67, s60, 6
    v_xor_b32 v110, s67, v108
    s_lshl_b32 s67, s62, 1
    s_add_u32 s67, s67, s60
    s_mul_i32 s67, s67, 7168
    v_add3_u32 v12, v109, v110, s67
    s_lshl_b32 s64, s58, 12
    s_lshl_b32 s65, s60, 13
    s_lshl_b32 s67, s59, 12
    s_add_u32 s65, s65, s67
    s_add_u32 s65, s65, 16384
    s_lshl_b32 s66, s58, 10
    s_add_u32 s66, s66, 32768
    s_waitcnt lgkmcnt(0)
    s_mov_b32 s24, s4
    s_mov_b32 s25, s5
    s_mov_b32 s26, 1835008
    s_mov_b32 s27, 0x20000
    s_cmp_ge_u32 s58, 2
    s_cselect_b32 s32, s10, s8
    s_cselect_b32 s33, s11, s9
    s_mov_b32 s34, 401408
    s_mov_b32 s35, 0x20000
    s_mov_b32 s28, s12
    s_mov_b32 s29, s13
    s_mov_b32 s30, 1605632
    s_mov_b32 s31, 0x20000
    s_movk_i32 s72, 0
    buffer_load_dwordx4 v[104:107], v4, s[24:27], s72 offen offset:0
    buffer_load_dwordx4 v[108:111], v5, s[24:27], s72 offen offset:1024
    buffer_load_dwordx4 v[112:115], v6, s[24:27], s72 offen offset:2048
    buffer_load_dwordx4 v[116:119], v7, s[24:27], s72 offen offset:3072
    s_movk_i32 s72, 128
    buffer_load_dwordx4 v[120:123], v4, s[24:27], s72 offen offset:0
    buffer_load_dwordx4 v[124:127], v5, s[24:27], s72 offen offset:1024
    buffer_load_dwordx4 v[128:131], v6, s[24:27], s72 offen offset:2048
    buffer_load_dwordx4 v[132:135], v7, s[24:27], s72 offen offset:3072
    s_movk_i32 s72, 256
    buffer_load_dwordx4 v[136:139], v4, s[24:27], s72 offen offset:0
    buffer_load_dwordx4 v[140:143], v5, s[24:27], s72 offen offset:1024
    buffer_load_dwordx4 v[144:147], v6, s[24:27], s72 offen offset:2048
    buffer_load_dwordx4 v[148:151], v7, s[24:27], s72 offen offset:3072
    s_movk_i32 s72, 384
    buffer_load_dwordx4 v[152:155], v4, s[24:27], s72 offen offset:0
    buffer_load_dwordx4 v[156:159], v5, s[24:27], s72 offen offset:1024
    buffer_load_dwordx4 v[160:163], v6, s[24:27], s72 offen offset:2048
    buffer_load_dwordx4 v[164:167], v7, s[24:27], s72 offen offset:3072
    s_movk_i32 s72, 512
    buffer_load_dwordx4 v[168:171], v4, s[24:27], s72 offen offset:0
    buffer_load_dwordx4 v[172:175], v5, s[24:27], s72 offen offset:1024
    buffer_load_dwordx4 v[176:179], v6, s[24:27], s72 offen offset:2048
    buffer_load_dwordx4 v[180:183], v7, s[24:27], s72 offen offset:3072
    s_movk_i32 s72, 640
    buffer_load_dwordx4 v[184:187], v4, s[24:27], s72 offen offset:0
    buffer_load_dwordx4 v[188:191], v5, s[24:27], s72 offen offset:1024
    buffer_load_dwordx4 v[192:195], v6, s[24:27], s72 offen offset:2048
    buffer_load_dwordx4 v[196:199], v7, s[24:27], s72 offen offset:3072
    s_movk_i32 s72, 768
    buffer_load_dwordx4 v[200:203], v4, s[24:27], s72 offen offset:0
    buffer_load_dwordx4 v[204:207], v5, s[24:27], s72 offen offset:1024
    buffer_load_dwordx4 v[208:211], v6, s[24:27], s72 offen offset:2048
    buffer_load_dwordx4 v[212:215], v7, s[24:27], s72 offen offset:3072
    buffer_load_dwordx4 v[224:227], v12, s[32:35], 0 offen offset:0
    buffer_load_dwordx4 v[228:231], v12, s[32:35], 0 offen offset:128
    buffer_load_dwordx4 v[232:235], v12, s[32:35], 0 offen offset:256
    buffer_load_dwordx4 v[236:239], v12, s[32:35], 0 offen offset:384
    buffer_load_dwordx4 v[240:243], v12, s[32:35], 0 offen offset:512
    buffer_load_dwordx4 v[244:247], v12, s[32:35], 0 offen offset:640
    buffer_load_dwordx4 v[248:251], v12, s[32:35], 0 offen offset:768
    s_sub_u32 s67, 14, s61
    s_mul_i32 s67, s67, 14336
    v_add_u32 v12, s67, v12
    s_mov_b32 s62, 14
    s_add_u32 s44, s18, 10485760
    s_addc_u32 s45, s19, 0
    s_mov_b32 s46, 131072
    s_mov_b32 s47, 0x20000
    s_load_dwordx2 s[56:57], s[44:45], 81920
    s_mov_b32 s36, s18
    s_mov_b32 s37, s19
    s_mov_b32 s38, 7602176
    s_mov_b32 s39, 0x20000
    s_add_u32 s40, s18, 8388608
    s_addc_u32 s41, s19, 0
    s_mov_b32 s42, 2097152
    s_mov_b32 s43, 0x20000
    s_mov_b32 s77, 0x3f803f80
    v_mov_b32 v92, 0
    v_mov_b32 v93, 0
    v_mov_b32 v94, 0
    v_mov_b32 v95, 0
    v_mov_b32 v96, 0
    v_mov_b32 v97, 0
    v_mov_b32 v98, 0
    v_mov_b32 v99, 0
    v_mov_b32 v100, 0
    s_waitcnt vmcnt(31)
    v_dot2c_f32_bf16 v92, s77, v104
    v_dot2c_f32_bf16 v96, v104, v104
    v_dot2c_f32_bf16 v93, s77, v108
    v_dot2c_f32_bf16 v97, v108, v108
    v_dot2c_f32_bf16 v94, s77, v112
    v_dot2c_f32_bf16 v98, v112, v112
    v_dot2c_f32_bf16 v95, s77, v116
    v_dot2c_f32_bf16 v99, v116, v116
    v_dot2c_f32_bf16 v92, s77, v105
    v_dot2c_f32_bf16 v96, v105, v105
    v_dot2c_f32_bf16 v93, s77, v109
    v_dot2c_f32_bf16 v97, v109, v109
    v_dot2c_f32_bf16 v94, s77, v113
    v_dot2c_f32_bf16 v98, v113, v113
    v_dot2c_f32_bf16 v95, s77, v117
    v_dot2c_f32_bf16 v99, v117, v117
    v_dot2c_f32_bf16 v92, s77, v106
    v_dot2c_f32_bf16 v96, v106, v106
    v_dot2c_f32_bf16 v93, s77, v110
    v_dot2c_f32_bf16 v97, v110, v110
    v_dot2c_f32_bf16 v94, s77, v114
    v_dot2c_f32_bf16 v98, v114, v114
    v_dot2c_f32_bf16 v95, s77, v118
    v_dot2c_f32_bf16 v99, v118, v118
    v_dot2c_f32_bf16 v92, s77, v107
    v_dot2c_f32_bf16 v96, v107, v107
    v_dot2c_f32_bf16 v93, s77, v111
    v_dot2c_f32_bf16 v97, v111, v111
    v_dot2c_f32_bf16 v94, s77, v115
    v_dot2c_f32_bf16 v98, v115, v115
    v_dot2c_f32_bf16 v95, s77, v119
    v_dot2c_f32_bf16 v99, v119, v119
    s_waitcnt vmcnt(27)
    v_dot2c_f32_bf16 v92, s77, v120
    v_dot2c_f32_bf16 v96, v120, v120
    v_dot2c_f32_bf16 v93, s77, v124
    v_dot2c_f32_bf16 v97, v124, v124
    v_dot2c_f32_bf16 v94, s77, v128
    v_dot2c_f32_bf16 v98, v128, v128
    v_dot2c_f32_bf16 v95, s77, v132
    v_dot2c_f32_bf16 v99, v132, v132
    v_dot2c_f32_bf16 v92, s77, v121
    v_dot2c_f32_bf16 v96, v121, v121
    v_dot2c_f32_bf16 v93, s77, v125
    v_dot2c_f32_bf16 v97, v125, v125
    v_dot2c_f32_bf16 v94, s77, v129
    v_dot2c_f32_bf16 v98, v129, v129
    v_dot2c_f32_bf16 v95, s77, v133
    v_dot2c_f32_bf16 v99, v133, v133
    v_dot2c_f32_bf16 v92, s77, v122
    v_dot2c_f32_bf16 v96, v122, v122
    v_dot2c_f32_bf16 v93, s77, v126
    v_dot2c_f32_bf16 v97, v126, v126
    v_dot2c_f32_bf16 v94, s77, v130
    v_dot2c_f32_bf16 v98, v130, v130
    v_dot2c_f32_bf16 v95, s77, v134
    v_dot2c_f32_bf16 v99, v134, v134
    v_dot2c_f32_bf16 v92, s77, v123
    v_dot2c_f32_bf16 v96, v123, v123
    v_dot2c_f32_bf16 v93, s77, v127
    v_dot2c_f32_bf16 v97, v127, v127
    v_dot2c_f32_bf16 v94, s77, v131
    v_dot2c_f32_bf16 v98, v131, v131
    v_dot2c_f32_bf16 v95, s77, v135
    v_dot2c_f32_bf16 v99, v135, v135
    s_waitcnt vmcnt(23)
    v_dot2c_f32_bf16 v92, s77, v136
    v_dot2c_f32_bf16 v96, v136, v136
    v_dot2c_f32_bf16 v93, s77, v140
    v_dot2c_f32_bf16 v97, v140, v140
    v_dot2c_f32_bf16 v94, s77, v144
    v_dot2c_f32_bf16 v98, v144, v144
    v_dot2c_f32_bf16 v95, s77, v148
    v_dot2c_f32_bf16 v99, v148, v148
    v_dot2c_f32_bf16 v92, s77, v137
    v_dot2c_f32_bf16 v96, v137, v137
    v_dot2c_f32_bf16 v93, s77, v141
    v_dot2c_f32_bf16 v97, v141, v141
    v_dot2c_f32_bf16 v94, s77, v145
    v_dot2c_f32_bf16 v98, v145, v145
    v_dot2c_f32_bf16 v95, s77, v149
    v_dot2c_f32_bf16 v99, v149, v149
    v_dot2c_f32_bf16 v92, s77, v138
    v_dot2c_f32_bf16 v96, v138, v138
    v_dot2c_f32_bf16 v93, s77, v142
    v_dot2c_f32_bf16 v97, v142, v142
    v_dot2c_f32_bf16 v94, s77, v146
    v_dot2c_f32_bf16 v98, v146, v146
    v_dot2c_f32_bf16 v95, s77, v150
    v_dot2c_f32_bf16 v99, v150, v150
    v_dot2c_f32_bf16 v92, s77, v139
    v_dot2c_f32_bf16 v96, v139, v139
    v_dot2c_f32_bf16 v93, s77, v143
    v_dot2c_f32_bf16 v97, v143, v143
    v_dot2c_f32_bf16 v94, s77, v147
    v_dot2c_f32_bf16 v98, v147, v147
    v_dot2c_f32_bf16 v95, s77, v151
    v_dot2c_f32_bf16 v99, v151, v151
    s_waitcnt vmcnt(19)
    v_dot2c_f32_bf16 v92, s77, v152
    v_dot2c_f32_bf16 v96, v152, v152
    v_dot2c_f32_bf16 v93, s77, v156
    v_dot2c_f32_bf16 v97, v156, v156
    v_dot2c_f32_bf16 v94, s77, v160
    v_dot2c_f32_bf16 v98, v160, v160
    v_dot2c_f32_bf16 v95, s77, v164
    v_dot2c_f32_bf16 v99, v164, v164
    v_dot2c_f32_bf16 v92, s77, v153
    v_dot2c_f32_bf16 v96, v153, v153
    v_dot2c_f32_bf16 v93, s77, v157
    v_dot2c_f32_bf16 v97, v157, v157
    v_dot2c_f32_bf16 v94, s77, v161
    v_dot2c_f32_bf16 v98, v161, v161
    v_dot2c_f32_bf16 v95, s77, v165
    v_dot2c_f32_bf16 v99, v165, v165
    v_dot2c_f32_bf16 v92, s77, v154
    v_dot2c_f32_bf16 v96, v154, v154
    v_dot2c_f32_bf16 v93, s77, v158
    v_dot2c_f32_bf16 v97, v158, v158
    v_dot2c_f32_bf16 v94, s77, v162
    v_dot2c_f32_bf16 v98, v162, v162
    v_dot2c_f32_bf16 v95, s77, v166
    v_dot2c_f32_bf16 v99, v166, v166
    v_dot2c_f32_bf16 v92, s77, v155
    v_dot2c_f32_bf16 v96, v155, v155
    v_dot2c_f32_bf16 v93, s77, v159
    v_dot2c_f32_bf16 v97, v159, v159
    v_dot2c_f32_bf16 v94, s77, v163
    v_dot2c_f32_bf16 v98, v163, v163
    v_dot2c_f32_bf16 v95, s77, v167
    v_dot2c_f32_bf16 v99, v167, v167
    s_waitcnt vmcnt(15)
    v_dot2c_f32_bf16 v92, s77, v168
    v_dot2c_f32_bf16 v96, v168, v168
    v_dot2c_f32_bf16 v93, s77, v172
    v_dot2c_f32_bf16 v97, v172, v172
    v_dot2c_f32_bf16 v94, s77, v176
    v_dot2c_f32_bf16 v98, v176, v176
    v_dot2c_f32_bf16 v95, s77, v180
    v_dot2c_f32_bf16 v99, v180, v180
    v_dot2c_f32_bf16 v92, s77, v169
    v_dot2c_f32_bf16 v96, v169, v169
    v_dot2c_f32_bf16 v93, s77, v173
    v_dot2c_f32_bf16 v97, v173, v173
    v_dot2c_f32_bf16 v94, s77, v177
    v_dot2c_f32_bf16 v98, v177, v177
    v_dot2c_f32_bf16 v95, s77, v181
    v_dot2c_f32_bf16 v99, v181, v181
    v_dot2c_f32_bf16 v92, s77, v170
    v_dot2c_f32_bf16 v96, v170, v170
    v_dot2c_f32_bf16 v93, s77, v174
    v_dot2c_f32_bf16 v97, v174, v174
    v_dot2c_f32_bf16 v94, s77, v178
    v_dot2c_f32_bf16 v98, v178, v178
    v_dot2c_f32_bf16 v95, s77, v182
    v_dot2c_f32_bf16 v99, v182, v182
    v_dot2c_f32_bf16 v92, s77, v171
    v_dot2c_f32_bf16 v96, v171, v171
    v_dot2c_f32_bf16 v93, s77, v175
    v_dot2c_f32_bf16 v97, v175, v175
    v_dot2c_f32_bf16 v94, s77, v179
    v_dot2c_f32_bf16 v98, v179, v179
    v_dot2c_f32_bf16 v95, s77, v183
    v_dot2c_f32_bf16 v99, v183, v183
    s_waitcnt vmcnt(11)
    v_dot2c_f32_bf16 v92, s77, v184
    v_dot2c_f32_bf16 v96, v184, v184
    v_dot2c_f32_bf16 v93, s77, v188
    v_dot2c_f32_bf16 v97, v188, v188
    v_dot2c_f32_bf16 v94, s77, v192
    v_dot2c_f32_bf16 v98, v192, v192
    v_dot2c_f32_bf16 v95, s77, v196
    v_dot2c_f32_bf16 v99, v196, v196
    v_dot2c_f32_bf16 v92, s77, v185
    v_dot2c_f32_bf16 v96, v185, v185
    v_dot2c_f32_bf16 v93, s77, v189
    v_dot2c_f32_bf16 v97, v189, v189
    v_dot2c_f32_bf16 v94, s77, v193
    v_dot2c_f32_bf16 v98, v193, v193
    v_dot2c_f32_bf16 v95, s77, v197
    v_dot2c_f32_bf16 v99, v197, v197
    v_dot2c_f32_bf16 v92, s77, v186
    v_dot2c_f32_bf16 v96, v186, v186
    v_dot2c_f32_bf16 v93, s77, v190
    v_dot2c_f32_bf16 v97, v190, v190
    v_dot2c_f32_bf16 v94, s77, v194
    v_dot2c_f32_bf16 v98, v194, v194
    v_dot2c_f32_bf16 v95, s77, v198
    v_dot2c_f32_bf16 v99, v198, v198
    v_dot2c_f32_bf16 v92, s77, v187
    v_dot2c_f32_bf16 v96, v187, v187
    v_dot2c_f32_bf16 v93, s77, v191
    v_dot2c_f32_bf16 v97, v191, v191
    v_dot2c_f32_bf16 v94, s77, v195
    v_dot2c_f32_bf16 v98, v195, v195
    v_dot2c_f32_bf16 v95, s77, v199
    v_dot2c_f32_bf16 v99, v199, v199
    s_waitcnt vmcnt(7)
    v_dot2c_f32_bf16 v92, s77, v200
    v_dot2c_f32_bf16 v96, v200, v200
    v_dot2c_f32_bf16 v93, s77, v204
    v_dot2c_f32_bf16 v97, v204, v204
    v_dot2c_f32_bf16 v94, s77, v208
    v_dot2c_f32_bf16 v98, v208, v208
    v_dot2c_f32_bf16 v95, s77, v212
    v_dot2c_f32_bf16 v99, v212, v212
    v_dot2c_f32_bf16 v92, s77, v201
    v_dot2c_f32_bf16 v96, v201, v201
    v_dot2c_f32_bf16 v93, s77, v205
    v_dot2c_f32_bf16 v97, v205, v205
    v_dot2c_f32_bf16 v94, s77, v209
    v_dot2c_f32_bf16 v98, v209, v209
    v_dot2c_f32_bf16 v95, s77, v213
    v_dot2c_f32_bf16 v99, v213, v213
    v_dot2c_f32_bf16 v92, s77, v202
    v_dot2c_f32_bf16 v96, v202, v202
    v_dot2c_f32_bf16 v93, s77, v206
    v_dot2c_f32_bf16 v97, v206, v206
    v_dot2c_f32_bf16 v94, s77, v210
    v_dot2c_f32_bf16 v98, v210, v210
    v_dot2c_f32_bf16 v95, s77, v214
    v_dot2c_f32_bf16 v99, v214, v214
    v_dot2c_f32_bf16 v92, s77, v203
    v_dot2c_f32_bf16 v96, v203, v203
    v_dot2c_f32_bf16 v93, s77, v207
    v_dot2c_f32_bf16 v97, v207, v207
    v_dot2c_f32_bf16 v94, s77, v211
    v_dot2c_f32_bf16 v98, v211, v211
    v_dot2c_f32_bf16 v95, s77, v215
    v_dot2c_f32_bf16 v99, v215, v215
    v_and_b32 v54, 3, v1
    s_nop 1
    v_add_f32_dpp v92, v92, v92 quad_perm:[1,0,3,2] row_mask:0xf bank_mask:0xf
    v_add_f32_dpp v93, v93, v93 quad_perm:[1,0,3,2] row_mask:0xf bank_mask:0xf
    v_add_f32_dpp v94, v94, v94 quad_perm:[1,0,3,2] row_mask:0xf bank_mask:0xf
    v_add_f32_dpp v95, v95, v95 quad_perm:[1,0,3,2] row_mask:0xf bank_mask:0xf
    v_add_f32_dpp v96, v96, v96 quad_perm:[1,0,3,2] row_mask:0xf bank_mask:0xf
    v_add_f32_dpp v97, v97, v97 quad_perm:[1,0,3,2] row_mask:0xf bank_mask:0xf
    v_add_f32_dpp v98, v98, v98 quad_perm:[1,0,3,2] row_mask:0xf bank_mask:0xf
    v_add_f32_dpp v99, v99, v99 quad_perm:[1,0,3,2] row_mask:0xf bank_mask:0xf
    v_add_f32_dpp v92, v92, v92 quad_perm:[2,3,0,1] row_mask:0xf bank_mask:0xf
    v_add_f32_dpp v93, v93, v93 quad_perm:[2,3,0,1] row_mask:0xf bank_mask:0xf
    v_add_f32_dpp v94, v94, v94 quad_perm:[2,3,0,1] row_mask:0xf bank_mask:0xf
    v_add_f32_dpp v95, v95, v95 quad_perm:[2,3,0,1] row_mask:0xf bank_mask:0xf
    v_add_f32_dpp v96, v96, v96 quad_perm:[2,3,0,1] row_mask:0xf bank_mask:0xf
    v_add_f32_dpp v97, v97, v97 quad_perm:[2,3,0,1] row_mask:0xf bank_mask:0xf
    v_add_f32_dpp v98, v98, v98 quad_perm:[2,3,0,1] row_mask:0xf bank_mask:0xf
    v_add_f32_dpp v99, v99, v99 quad_perm:[2,3,0,1] row_mask:0xf bank_mask:0xf
    v_add_f32_dpp v92, v92, v92 row_half_mirror row_mask:0xf bank_mask:0xf
    v_add_f32_dpp v93, v93, v93 row_half_mirror row_mask:0xf bank_mask:0xf
    v_add_f32_dpp v94, v94, v94 row_half_mirror row_mask:0xf bank_mask:0xf
    v_add_f32_dpp v95, v95, v95 row_half_mirror row_mask:0xf bank_mask:0xf
    v_add_f32_dpp v96, v96, v96 row_half_mirror row_mask:0xf bank_mask:0xf
    v_add_f32_dpp v97, v97, v97 row_half_mirror row_mask:0xf bank_mask:0xf
    v_add_f32_dpp v98, v98, v98 row_half_mirror row_mask:0xf bank_mask:0xf
    v_add_f32_dpp v99, v99, v99 row_half_mirror row_mask:0xf bank_mask:0xf
    v_cmp_eq_u32 vcc, 1, v54
    s_nop 1
    v_cndmask_b32 v92, v92, v93, vcc
    v_cndmask_b32 v96, v96, v97, vcc
    v_cmp_eq_u32 vcc, 2, v54
    s_nop 1
    v_cndmask_b32 v92, v92, v94, vcc
    v_cndmask_b32 v96, v96, v98, vcc
    v_cmp_eq_u32 vcc, 3, v54
    s_nop 1
    v_cndmask_b32 v92, v92, v95, vcc
    v_cndmask_b32 v96, v96, v99, vcc
    v_mul_f32 v52, 0x3b124925, v92
    v_mul_f32 v49, 0x3b124925, v96
    v_fma_f32 v49, -v52, v52, v49
    v_max_f32 v49, 0, v49
    v_cvt_pk_bf16_f32 v48, -v52, -v52
    v_cvt_pk_bf16_f32 v49, v49, v49
    v_and_b32 v49, 0xffff0000, v49
    v_add_f32 v49, 0x3727c5ac, v49
    v_cvt_pk_bf16_f32 v49, v49, v49
    v_and_b32 v49, 0xffff0000, v49
    v_sqrt_f32 v49, v49
    s_nop 0
    v_cvt_pk_bf16_f32 v49, v49, v49
    v_and_b32 v49, 0xffff0000, v49
    v_rcp_f32 v49, v49
    s_waitcnt lgkmcnt(0)
    s_add_u32 s56, s56, 0x7f4a7c15
    s_addc_u32 s57, s57, 0x9e3779b9
    v_mov_b32 v50, s56
    v_mov_b32 v51, s57
    v_lshrrev_b32 v55, 3, v1
    v_lshl_add_u32 v53, v54, 3, v55
    v_lshlrev_b32 v53, 4, v53
    s_lshl_b32 s67, s63, 9
    buffer_store_dwordx4 v[48:51], v53, s[44:47], s67 offen sc1
    s_waitcnt vmcnt(1)
    v_dot2c_f32_bf16 v100, s77, v224
    v_dot2c_f32_bf16 v100, s77, v225
    v_dot2c_f32_bf16 v100, s77, v226
    v_dot2c_f32_bf16 v100, s77, v227
    v_dot2c_f32_bf16 v100, s77, v228
    v_dot2c_f32_bf16 v100, s77, v229
    v_dot2c_f32_bf16 v100, s77, v230
    v_dot2c_f32_bf16 v100, s77, v231
    v_dot2c_f32_bf16 v100, s77, v232
    v_dot2c_f32_bf16 v100, s77, v233
    v_dot2c_f32_bf16 v100, s77, v234
    v_dot2c_f32_bf16 v100, s77, v235
    v_dot2c_f32_bf16 v100, s77, v236
    v_dot2c_f32_bf16 v100, s77, v237
    v_dot2c_f32_bf16 v100, s77, v238
    v_dot2c_f32_bf16 v100, s77, v239
    v_dot2c_f32_bf16 v100, s77, v240
    v_dot2c_f32_bf16 v100, s77, v241
    v_dot2c_f32_bf16 v100, s77, v242
    v_dot2c_f32_bf16 v100, s77, v243
    v_dot2c_f32_bf16 v100, s77, v244
    v_dot2c_f32_bf16 v100, s77, v245
    v_dot2c_f32_bf16 v100, s77, v246
    v_dot2c_f32_bf16 v100, s77, v247
    v_dot2c_f32_bf16 v100, s77, v248
    v_dot2c_f32_bf16 v100, s77, v249
    v_dot2c_f32_bf16 v100, s77, v250
    v_dot2c_f32_bf16 v100, s77, v251
    s_nop 2
    v_add_f32_dpp v100, v100, v100 quad_perm:[1,0,3,2] row_mask:0xf bank_mask:0xf
    s_nop 1
    v_add_f32_dpp v100, v100, v100 quad_perm:[2,3,0,1] row_mask:0xf bank_mask:0xf
    s_nop 1
    v_add_f32_dpp v100, v100, v100 row_half_mirror row_mask:0xf bank_mask:0xf
    s_nop 1
    v_cvt_pk_bf16_f32 v226, v100, v100
    v_and_b32 v227, 0xffff0000, v226
    v_sub_f32 v228, v100, v227
    v_cvt_pk_bf16_f32 v224, v100, v228
    v_and_b32 v227, 0xffff0000, v224
    v_sub_f32 v228, v228, v227
    v_cvt_pk_bf16_f32 v225, v228, 0
    v_mov_b32 v226, s56
    v_mov_b32 v227, s57
    v_lshlrev_b32 v55, 4, v55
    s_lshl_b32 s67, s61, 9
    s_lshl_b32 s68, s58, 7
    s_add_u32 s67, s67, s68
    s_add_u32 s67, s67, 98304
    buffer_store_dwordx4 v[224:227], v55, s[44:47], s67 offen sc1
    s_movk_i32 s72, 0
    s_mov_b32 s73, 0
    s_add_u32 m0, s64, 0
    s_nop 0
    buffer_load_dwordx4 v4, s[24:27], s72 offen offset:0 lds
    buffer_load_dwordx4 v5, s[24:27], s72 offen offset:1024 lds
    buffer_load_dwordx4 v6, s[24:27], s72 offen offset:2048 lds
    buffer_load_dwordx4 v7, s[24:27], s72 offen offset:3072 lds
    s_add_u32 m0, s66, 0
    s_nop 0
    buffer_load_dwordx4 v12, s[32:35], s72 offen lds
    s_movk_i32 s72, 128
    s_mov_b32 s73, 229376
    s_add_u32 m0, s64, 36864
    s_nop 0
    buffer_load_dwordx4 v4, s[24:27], s72 offen offset:0 lds
    buffer_load_dwordx4 v5, s[24:27], s72 offen offset:1024 lds
    buffer_load_dwordx4 v6, s[24:27], s72 offen offset:2048 lds
    buffer_load_dwordx4 v7, s[24:27], s72 offen offset:3072 lds
    s_add_u32 m0, s66, 36864
    s_nop 0
    buffer_load_dwordx4 v12, s[32:35], s72 offen lds
    s_movk_i32 s72, 256
    s_mov_b32 s73, 458752
    s_add_u32 m0, s64, 73728
    s_nop 0
    buffer_load_dwordx4 v4, s[24:27], s72 offen offset:0 lds
    buffer_load_dwordx4 v5, s[24:27], s72 offen offset:1024 lds
    buffer_load_dwordx4 v6, s[24:27], s72 offen offset:2048 lds
    buffer_load_dwordx4 v7, s[24:27], s72 offen offset:3072 lds
    s_add_u32 m0, s66, 73728
    s_nop 0
    buffer_load_dwordx4 v12, s[32:35], s72 offen lds
    s_movk_i32 s72, 384
    s_mov_b32 s73, 688128
    s_add_u32 m0, s64, 110592
    s_nop 0
    buffer_load_dwordx4 v4, s[24:27], s72 offen offset:0 lds
    buffer_load_dwordx4 v5, s[24:27], s72 offen offset:1024 lds
    buffer_load_dwordx4 v6, s[24:27], s72 offen offset:2048 lds
    buffer_load_dwordx4 v7, s[24:27], s72 offen offset:3072 lds
    s_add_u32 m0, s66, 110592
    s_nop 0
    buffer_load_dwordx4 v12, s[32:35], s72 offen lds
    v_and_b32 v2, 31, v1
    v_lshrrev_b32 v3, 5, v1
    v_bfe_u32 v104, v2, 1, 3
    v_xor_b32 v104, v104, v3
    v_lshlrev_b32 v105, 7, v2
    s_xor_b32 s67, s58, 1
    s_lshl_b32 s67, s67, 12
    v_xor_b32 v106, 0, v104
    v_lshl_add_u32 v106, v106, 4, v105
    v_add_u32 v13, s64, v106
    v_add_u32 v21, s67, v106
    v_add_u32 v29, 0x8000, v106
    v_add_u32 v17, 73728, v13
    v_add_u32 v25, 73728, v21
    v_add_u32 v33, 73728, v29
    v_xor_b32 v106, 2, v104
    v_lshl_add_u32 v106, v106, 4, v105
    v_add_u32 v14, s64, v106
    v_add_u32 v22, s67, v106
    v_add_u32 v30, 0x8000, v106
    v_add_u32 v18, 73728, v14
    v_add_u32 v26, 73728, v22
    v_add_u32 v34, 73728, v30
    v_xor_b32 v106, 4, v104
    v_lshl_add_u32 v106, v106, 4, v105
    v_add_u32 v15, s64, v106
    v_add_u32 v23, s67, v106
    v_add_u32 v31, 0x8000, v106
    v_add_u32 v19, 73728, v15
    v_add_u32 v27, 73728, v23
    v_add_u32 v35, 73728, v31
    v_xor_b32 v106, 6, v104
    v_lshl_add_u32 v106, v106, 4, v105
    v_add_u32 v16, s64, v106
    v_add_u32 v24, s67, v106
    v_add_u32 v32, 0x8000, v106
    v_add_u32 v20, 73728, v16
    v_add_u32 v28, 73728, v24
    v_add_u32 v36, 73728, v32
    v_bfe_u32 v104, v1, 2, 2
    v_lshl_add_u32 v105, v3, 3, v104
    v_lshlrev_b32 v105, 7, v105
    v_lshrrev_b32 v104, 1, v104
    v_xor_b32 v104, s59, v104
    v_lshl_add_u32 v105, v104, 6, v105
    v_bfe_u32 v104, v1, 4, 1
    v_lshl_add_u32 v105, v104, 5, v105
    v_and_b32 v104, 3, v1
    v_lshl_add_u32 v105, v104, 3, v105
    s_lshl_b32 s67, s60, 13
    s_add_u32 s67, s67, 16384
    v_add_u32 v37, s67, v105
    v_xor_b32 v39, 64, v37
    v_add_u32 v38, 73728, v37
    v_add_u32 v40, 73728, v39
    s_lshl_b32 s79, s62, 4
    s_add_u32 s79, s79, s61
    s_lshl_b32 s79, s79, 3
    s_add_u32 s79, s79, 69632
    s_lshl_b32 s80, s61, 4
    s_add_u32 s80, s80, s62
    s_lshl_b32 s80, s80, 3
    s_add_u32 s80, s80, 65536
    s_sub_u32 s80, s80, s79
    v_mul_lo_u32 v94, v1, s80
    v_add_u32 v94, s79, v94
    v_mov_b32 v92, s56
    v_mov_b32 v93, s57
    v_lshlrev_b32 v42, 4, v2
    v_add_u32 v41, -1, v3
    s_lshl_b32 s79, s58, 7
    s_add_u32 s79, s79, 155648
    v_lshl_add_u32 v44, v2, 2, s79
    v_lshl_add_u32 v43, v3, 4, s79
    v_cvt_f32_u32 v84, v2
    v_cvt_f32_u32 v85, v3
    v_mul_f32 v84, 0x3d000000, v84
    v_mul_f32 v85, 4.0, v85
    v_mul_f32 v85, v85, v84
    v_fmamk_f32 v86, v84, 0x00000000, v85
    v_fmamk_f32 v87, v84, 0x3f800000, v85
    v_cos_f32 v88, v86
    v_cos_f32 v89, v87
    v_sin_f32 v90, v86
    v_sin_f32 v91, v87
    v_cvt_pk_bf16_f32 v56, v88, v89
    v_cvt_pk_bf16_f32 v64, -v90, -v91
    v_fmamk_f32 v86, v84, 0x40000000, v85
    v_fmamk_f32 v87, v84, 0x40400000, v85
    v_cos_f32 v88, v86
    v_cos_f32 v89, v87
    v_sin_f32 v90, v86
    v_sin_f32 v91, v87
    v_cvt_pk_bf16_f32 v57, v88, v89
    v_cvt_pk_bf16_f32 v65, -v90, -v91
    v_fmamk_f32 v86, v84, 0x41000000, v85
    v_fmamk_f32 v87, v84, 0x41100000, v85
    v_cos_f32 v88, v86
    v_cos_f32 v89, v87
    v_sin_f32 v90, v86
    v_sin_f32 v91, v87
    v_cvt_pk_bf16_f32 v58, v88, v89
    v_cvt_pk_bf16_f32 v66, -v90, -v91
    v_fmamk_f32 v86, v84, 0x41200000, v85
    v_fmamk_f32 v87, v84, 0x41300000, v85
    v_cos_f32 v88, v86
    v_cos_f32 v89, v87
    v_sin_f32 v90, v86
    v_sin_f32 v91, v87
    v_cvt_pk_bf16_f32 v59, v88, v89
    v_cvt_pk_bf16_f32 v67, -v90, -v91
    v_fmamk_f32 v86, v84, 0x41800000, v85
    v_fmamk_f32 v87, v84, 0x41880000, v85
    v_cos_f32 v88, v86
    v_cos_f32 v89, v87
    v_sin_f32 v90, v86
    v_sin_f32 v91, v87
    v_cvt_pk_bf16_f32 v60, v88, v89
    v_cvt_pk_bf16_f32 v68, -v90, -v91
    v_fmamk_f32 v86, v84, 0x41900000, v85
    v_fmamk_f32 v87, v84, 0x41980000, v85
    v_cos_f32 v88, v86
    v_cos_f32 v89, v87
    v_sin_f32 v90, v86
    v_sin_f32 v91, v87
    v_cvt_pk_bf16_f32 v61, v88, v89
    v_cvt_pk_bf16_f32 v69, -v90, -v91
    v_fmamk_f32 v86, v84, 0x41c00000, v85
    v_fmamk_f32 v87, v84, 0x41c80000, v85
    v_cos_f32 v88, v86
    v_cos_f32 v89, v87
    v_sin_f32 v90, v86
    v_sin_f32 v91, v87
    v_cvt_pk_bf16_f32 v62, v88, v89
    v_cvt_pk_bf16_f32 v70, -v90, -v91
    v_fmamk_f32 v86, v84, 0x41d00000, v85
    v_fmamk_f32 v87, v84, 0x41d80000, v85
    v_cos_f32 v88, v86
    v_cos_f32 v89, v87
    v_sin_f32 v90, v86
    v_sin_f32 v91, v87
    v_cvt_pk_bf16_f32 v63, v88, v89
    v_cvt_pk_bf16_f32 v71, -v90, -v91
    v_bfe_u32 v84, v1, 4, 1
    v_xor_b32 v78, 1, v84
    v_mul_u32_u24 v78, 0x8000, v78
    v_lshl_or_b32 v78, v78, 16, v78
    v_lshl_add_u32 v84, v3, 2, v84
    v_lshlrev_b32 v84, 8, v84
    v_and_b32 v85, 15, v1
    v_lshl_add_u32 v84, v85, 4, v84
    s_lshl_b32 s79, s58, 2
    s_add_u32 s79, s79, 147456
    v_add_u32 v79, s79, v84
    s_lshl_b32 s79, s58, 11
    s_add_u32 s79, s79, 147456
    v_lshlrev_b32 v82, 4, v1
    v_add_u32 v80, s79, v82
    v_lshrrev_b32 v84, 4, v1
    v_lshlrev_b32 v84, 16, v84
    v_lshl_add_u32 v84, v85, 4, v84
    s_lshl_b32 s79, s58, 19
    s_lshl_b32 s80, s61, 12
    s_add_u32 s79, s79, s80
    s_lshl_b32 s80, s62, 8
    s_add_u32 s79, s79, s80
    v_add_u32 v81, s79, v84
    s_mov_b32 exec_lo, 0x00010001
    s_mov_b32 exec_hi, 0x00010001
    buffer_load_dword v46, v81, s[40:43], 0 offen
    s_mov_b32 s67, 262144
    buffer_load_dword v46, v81, s[40:43], s67 offen
    s_mov_b64 exec, -1
    s_waitcnt vmcnt(17)
    s_barrier
    ds_read_b128 v[104:107], v13 offset:0
    ds_read_b128 v[108:111], v29 offset:0
    ds_read_b128 v[112:115], v14 offset:0
    ds_read_b128 v[116:119], v30 offset:0
    ds_read_b128 v[120:123], v15 offset:0
    ds_read_b128 v[124:127], v31 offset:0
    ds_read_b128 v[128:131], v16 offset:0
    ds_read_b128 v[132:135], v32 offset:0
    s_waitcnt lgkmcnt(0)
    s_waitcnt vmcnt(12)
    s_barrier
    ds_read_b128 v[160:163], v13 offset:36864
    ds_read_b128 v[164:167], v29 offset:36864
    ds_read_b128 v[168:171], v14 offset:36864
    ds_read_b128 v[172:175], v30 offset:36864
    ds_read_b128 v[176:179], v15 offset:36864
    ds_read_b128 v[180:183], v31 offset:36864
    ds_read_b128 v[184:187], v16 offset:36864
    ds_read_b128 v[188:191], v32 offset:36864
    s_movk_i32 s72, 512
    s_mov_b32 s73, 917504
    s_add_u32 m0, s64, 0
    s_nop 0
    buffer_load_dwordx4 v4, s[24:27], s72 offen offset:0 lds
    buffer_load_dwordx4 v5, s[24:27], s72 offen offset:1024 lds
    buffer_load_dwordx4 v6, s[24:27], s72 offen offset:2048 lds
    buffer_load_dwordx4 v7, s[24:27], s72 offen offset:3072 lds
    s_add_u32 m0, s66, 0
    s_nop 0
    buffer_load_dwordx4 v12, s[32:35], s72 offen lds
    v_mfma_f32_32x32x16_bf16 v[208:223], v[104:107], v[108:111], 0
    v_mfma_f32_32x32x16_bf16 v[208:223], v[112:115], v[116:119], v[208:223]
    v_mfma_f32_32x32x16_bf16 v[208:223], v[120:123], v[124:127], v[208:223]
    v_mfma_f32_32x32x16_bf16 v[208:223], v[128:131], v[132:135], v[208:223]
    s_waitcnt lgkmcnt(0)
    s_waitcnt vmcnt(12)
    s_barrier
    ds_read_b128 v[104:107], v17 offset:0
    ds_read_b128 v[108:111], v33 offset:0
    ds_read_b128 v[112:115], v18 offset:0
    ds_read_b128 v[116:119], v34 offset:0
    ds_read_b128 v[120:123], v19 offset:0
    ds_read_b128 v[124:127], v35 offset:0
    ds_read_b128 v[128:131], v20 offset:0
    ds_read_b128 v[132:135], v36 offset:0
    s_movk_i32 s72, 640
    s_mov_b32 s73, 1146880
    s_add_u32 m0, s64, 36864
    s_nop 0
    buffer_load_dwordx4 v4, s[24:27], s72 offen offset:0 lds
    buffer_load_dwordx4 v5, s[24:27], s72 offen offset:1024 lds
    buffer_load_dwordx4 v6, s[24:27], s72 offen offset:2048 lds
    buffer_load_dwordx4 v7, s[24:27], s72 offen offset:3072 lds
    s_add_u32 m0, s66, 36864
    s_nop 0
    buffer_load_dwordx4 v12, s[32:35], s72 offen lds
    v_mfma_f32_32x32x16_bf16 v[208:223], v[160:163], v[164:167], v[208:223]
    v_mfma_f32_32x32x16_bf16 v[208:223], v[168:171], v[172:175], v[208:223]
    v_mfma_f32_32x32x16_bf16 v[208:223], v[176:179], v[180:183], v[208:223]
    v_mfma_f32_32x32x16_bf16 v[208:223], v[184:187], v[188:191], v[208:223]
    s_waitcnt lgkmcnt(0)
    s_waitcnt vmcnt(12)
    s_barrier
    ds_read_b128 v[160:163], v17 offset:36864
    ds_read_b128 v[164:167], v33 offset:36864
    ds_read_b128 v[168:171], v18 offset:36864
    ds_read_b128 v[172:175], v34 offset:36864
    ds_read_b128 v[176:179], v19 offset:36864
    ds_read_b128 v[180:183], v35 offset:36864
    ds_read_b128 v[184:187], v20 offset:36864
    ds_read_b128 v[188:191], v36 offset:36864
    s_movk_i32 s72, 768
    s_mov_b32 s73, 1376256
    s_add_u32 m0, s64, 73728
    s_nop 0
    buffer_load_dwordx4 v4, s[24:27], s72 offen offset:0 lds
    buffer_load_dwordx4 v5, s[24:27], s72 offen offset:1024 lds
    buffer_load_dwordx4 v6, s[24:27], s72 offen offset:2048 lds
    buffer_load_dwordx4 v7, s[24:27], s72 offen offset:3072 lds
    s_add_u32 m0, s66, 73728
    s_nop 0
    buffer_load_dwordx4 v12, s[32:35], s72 offen lds
    v_mfma_f32_32x32x16_bf16 v[208:223], v[104:107], v[108:111], v[208:223]
    v_mfma_f32_32x32x16_bf16 v[208:223], v[112:115], v[116:119], v[208:223]
    v_mfma_f32_32x32x16_bf16 v[208:223], v[120:123], v[124:127], v[208:223]
    v_mfma_f32_32x32x16_bf16 v[208:223], v[128:131], v[132:135], v[208:223]
    s_waitcnt lgkmcnt(0)
    s_waitcnt vmcnt(10)
    s_barrier
    ds_read_b128 v[104:107], v13 offset:0
    ds_read_b128 v[108:111], v29 offset:0
    ds_read_b128 v[112:115], v14 offset:0
    ds_read_b128 v[116:119], v30 offset:0
    ds_read_b128 v[120:123], v15 offset:0
    ds_read_b128 v[124:127], v31 offset:0
    ds_read_b128 v[128:131], v16 offset:0
    ds_read_b128 v[132:135], v32 offset:0
    v_mfma_f32_32x32x16_bf16 v[208:223], v[160:163], v[164:167], v[208:223]
    v_mfma_f32_32x32x16_bf16 v[208:223], v[168:171], v[172:175], v[208:223]
    v_mfma_f32_32x32x16_bf16 v[208:223], v[176:179], v[180:183], v[208:223]
    v_mfma_f32_32x32x16_bf16 v[208:223], v[184:187], v[188:191], v[208:223]
    s_waitcnt lgkmcnt(0)
    s_waitcnt vmcnt(5)
    s_barrier
    ds_read_b128 v[160:163], v13 offset:36864
    ds_read_b128 v[164:167], v29 offset:36864
    ds_read_b128 v[168:171], v14 offset:36864
    ds_read_b128 v[172:175], v30 offset:36864
    ds_read_b128 v[176:179], v15 offset:36864
    ds_read_b128 v[180:183], v31 offset:36864
    ds_read_b128 v[184:187], v16 offset:36864
    ds_read_b128 v[188:191], v32 offset:36864
    s_lshl_b32 s74, s63, 9
    buffer_load_dwordx4 v[224:227], v42, s[44:47], s74 offen sc1
    s_lshl_b32 s74, s62, 9
    s_add_u32 s74, s74, 98304
    buffer_load_dwordx4 v[100:103], v42, s[44:47], s74 offen sc1
    v_mfma_f32_32x32x16_bf16 v[208:223], v[104:107], v[108:111], v[208:223]
    v_mfma_f32_32x32x16_bf16 v[208:223], v[112:115], v[116:119], v[208:223]
    v_mfma_f32_32x32x16_bf16 v[208:223], v[120:123], v[124:127], v[208:223]
    v_mfma_f32_32x32x16_bf16 v[208:223], v[128:131], v[132:135], v[208:223]
    s_waitcnt lgkmcnt(0)
    s_waitcnt vmcnt(2)
    s_barrier
    ds_read_b128 v[104:107], v17 offset:0
    ds_read_b128 v[108:111], v33 offset:0
    ds_read_b128 v[112:115], v18 offset:0
    ds_read_b128 v[116:119], v34 offset:0
    ds_read_b128 v[120:123], v19 offset:0
    ds_read_b128 v[124:127], v35 offset:0
    ds_read_b128 v[128:131], v20 offset:0
    ds_read_b128 v[132:135], v36 offset:0
    v_mfma_f32_32x32x16_bf16 v[208:223], v[160:163], v[164:167], v[208:223]
    v_mfma_f32_32x32x16_bf16 v[208:223], v[168:171], v[172:175], v[208:223]
    v_mfma_f32_32x32x16_bf16 v[208:223], v[176:179], v[180:183], v[208:223]
    v_mfma_f32_32x32x16_bf16 v[208:223], v[184:187], v[188:191], v[208:223]
    s_waitcnt lgkmcnt(0)
    v_mfma_f32_32x32x16_bf16 v[208:223], v[104:107], v[108:111], v[208:223]
    v_mfma_f32_32x32x16_bf16 v[208:223], v[112:115], v[116:119], v[208:223]
    v_mfma_f32_32x32x16_bf16 v[208:223], v[120:123], v[124:127], v[208:223]
    v_mfma_f32_32x32x16_bf16 v[208:223], v[128:131], v[132:135], v[208:223]
    s_waitcnt vmcnt(0)
    v_cmp_ne_u64 vcc, s[56:57], v[226:227]
    v_cmp_ne_u64 s[22:23], s[56:57], v[102:103]
    s_or_b64 vcc, vcc, s[22:23]
    s_cbranch_vccz Lok_6
    s_mov_b32 s78, 131072
Lspin_7:
    s_lshl_b32 s74, s63, 9
    buffer_load_dwordx4 v[224:227], v42, s[44:47], s74 offen sc1
    s_lshl_b32 s74, s62, 9
    s_add_u32 s74, s74, 98304
    buffer_load_dwordx4 v[100:103], v42, s[44:47], s74 offen sc1
    s_sub_u32 s78, s78, 1
    s_cbranch_scc1 Lok_6
    s_waitcnt vmcnt(0)
    v_cmp_ne_u64 vcc, s[56:57], v[226:227]
    v_cmp_ne_u64 s[22:23], s[56:57], v[102:103]
    s_or_b64 vcc, vcc, s[22:23]
    s_cbranch_vccnz Lspin_7
Lok_6:
    ds_write_b32 v44, v225
    v_and_b32 v224, v224, v41
    v_and_b32 v225, 0xffff, v224
    v_mov_b32 v226, 0
    v_mov_b32 v227, 0
    v_mov_b32 v102, 0
    v_mov_b32 v103, 0
    ds_read_b128 v[240:243], v43 offset:0
    ds_read_b128 v[244:247], v43 offset:32
    ds_read_b128 v[248:251], v43 offset:64
    ds_read_b128 v[252:255], v43 offset:96
    s_nop 1
    v_mfma_f32_32x32x16_bf16 v[208:223], v[224:227], v[100:103], v[208:223]
    s_nop 11
    s_waitcnt lgkmcnt(0)
    v_mul_f32 v208, v208, v240
    v_mul_f32 v209, v209, v241
    v_mul_f32 v210, v210, v242
    v_mul_f32 v211, v211, v243
    v_mul_f32 v212, v212, v244
    v_mul_f32 v213, v213, v245
    v_mul_f32 v214, v214, v246
    v_mul_f32 v215, v215, v247
    v_mul_f32 v216, v216, v248
    v_mul_f32 v217, v217, v249
    v_mul_f32 v218, v218, v250
    v_mul_f32 v219, v219, v251
    v_mul_f32 v220, v220, v252
    v_mul_f32 v221, v221, v253
    v_mul_f32 v222, v222, v254
    v_mul_f32 v223, v223, v255
    v_cvt_pk_bf16_f32 v104, v208, v209
    v_cvt_pk_bf16_f32 v105, v210, v211
    v_cvt_pk_bf16_f32 v106, v212, v213
    v_cvt_pk_bf16_f32 v107, v214, v215
    v_cvt_pk_bf16_f32 v108, v216, v217
    v_cvt_pk_bf16_f32 v109, v218, v219
    v_cvt_pk_bf16_f32 v110, v220, v221
    v_cvt_pk_bf16_f32 v111, v222, v223
    ds_swizzle_b32 v112, v104 offset:0x401f
    ds_swizzle_b32 v113, v105 offset:0x401f
    ds_swizzle_b32 v114, v106 offset:0x401f
    ds_swizzle_b32 v115, v107 offset:0x401f
    ds_swizzle_b32 v116, v108 offset:0x401f
    ds_swizzle_b32 v117, v109 offset:0x401f
    ds_swizzle_b32 v118, v110 offset:0x401f
    ds_swizzle_b32 v119, v111 offset:0x401f
    v_mfma_f32_32x32x16_bf16 v[208:223], v[56:59], v[104:107], 0
    v_mfma_f32_32x32x16_bf16 v[208:223], v[60:63], v[108:111], v[208:223]
    s_waitcnt lgkmcnt(0)
    v_xor_b32 v112, v112, v78
    v_xor_b32 v113, v113, v78
    v_xor_b32 v114, v114, v78
    v_xor_b32 v115, v115, v78
    v_xor_b32 v116, v116, v78
    v_xor_b32 v117, v117, v78
    v_xor_b32 v118, v118, v78
    v_xor_b32 v119, v119, v78
    s_nop 1
    v_mfma_f32_32x32x16_bf16 v[208:223], v[64:67], v[112:115], v[208:223]
    v_mfma_f32_32x32x16_bf16 v[208:223], v[68:71], v[116:119], v[208:223]
    s_nop 11
    v_permlane16_swap_b32 v208, v209
    v_permlane16_swap_b32 v210, v211
    v_permlane16_swap_b32 v212, v213
    v_permlane16_swap_b32 v214, v215
    v_permlane16_swap_b32 v216, v217
    v_permlane16_swap_b32 v218, v219
    v_permlane16_swap_b32 v220, v221
    v_permlane16_swap_b32 v222, v223
    s_nop 1
    v_cvt_pk_bf16_f32 v104, v208, v209
    v_cvt_pk_bf16_f32 v105, v210, v211
    v_cvt_pk_bf16_f32 v106, v212, v213
    v_cvt_pk_bf16_f32 v107, v214, v215
    v_cvt_pk_bf16_f32 v108, v216, v217
    v_cvt_pk_bf16_f32 v109, v218, v219
    v_cvt_pk_bf16_f32 v110, v220, v221
    v_cvt_pk_bf16_f32 v111, v222, v223
    ds_write_b32 v79, v104 offset:0
    ds_write_b32 v79, v105 offset:512
    ds_write_b32 v79, v106 offset:2048
    ds_write_b32 v79, v107 offset:2560
    ds_write_b32 v79, v108 offset:4096
    ds_write_b32 v79, v109 offset:4608
    ds_write_b32 v79, v110 offset:6144
    ds_write_b32 v79, v111 offset:6656
    s_waitcnt lgkmcnt(0)
    s_barrier
    ds_read_b128 v[112:115], v80
    ds_read_b128 v[116:119], v80 offset:1024
    s_mov_b32 s67, 262144
    s_waitcnt lgkmcnt(0)
    buffer_store_dwordx4 v[112:115], v81, s[40:43], 0 offen sc1
    buffer_store_dwordx4 v[116:119], v81, s[40:43], s67 offen sc1
    s_waitcnt vmcnt(0)
    s_barrier
    s_cmp_lg_u32 s58, 0
    s_cbranch_scc1 Lnofl_8
    s_mov_b64 exec, 3
    buffer_store_dwordx2 v[92:93], v94, s[44:47], 0 offen sc1
    s_mov_b64 exec, -1
Lnofl_8:
    s_branch Lfin
LroleC:
    s_lshl_b32 s69, s67, 1
    s_add_u32 s69, s69, s76
    s_sub_u32 s69, s69, 30
    s_lshl_b32 s61, s68, 3
    s_add_u32 s61, s61, s69
    s_mul_i32 s62, s68, 7
    s_add_u32 s62, s62, s69
    s_add_u32 s68, s68, 14
    s_cmp_eq_u32 s69, 7
    s_cselect_b32 s62, s68, s62
    s_lshl_b32 s63, s61, 1
    s_add_u32 s63, s63, s60
    s_lshl_b32 s67, s59, 5
    s_add_u32 s63, s63, s67
    v_lshrrev_b32 v105, 3, v1
    v_and_b32 v106, 7, v1
    v_lshrrev_b32 v107, 1, v105
    v_xor_b32 v108, v106, v107
    v_lshlrev_b32 v108, 4, v108
    v_mul_u32_u24 v109, 57344, v105
    s_mul_i32 s67, s63, 896
    v_add3_u32 v4, v109, v108, s67
    v_xor_b32 v5, 64, v4
    v_add_u32 v6, 915456, v4
    v_add_u32 v7, 1373184, v5
    v_add_u32 v5, 457728, v5
    v_and_b32 v110, 1, v107
    v_lshlrev_b32 v110, 2, v110
    v_xor_b32 v110, v110, v106
    v_lshlrev_b32 v110, 4, v110
    v_mul_u32_u24 v111, 3584, v105
    s_mul_i32 s67, s59, 114688
    s_lshl_b32 s68, s62, 8
    s_add_u32 s67, s67, s68
    s_lshl_b32 s68, s60, 7
    s_add_u32 s67, s67, s68
    v_add3_u32 v8, v111, v110, s67
    v_add_u32 v9, 27648, v8
    v_add_u32 v10, 55296, v8
    v_add_u32 v11, 82944, v8
    v_mul_u32_u24 v109, 896, v105
    s_lshl_b32 s67, s60, 6
    v_xor_b32 v110, s67, v108
    s_lshl_b32 s67, s62, 1
    s_add_u32 s67, s67, s60
    s_mul_i32 s67, s67, 7168
    v_add3_u32 v12, v109, v110, s67
    s_lshl_b32 s64, s58, 12
    s_lshl_b32 s65, s60, 13
    s_lshl_b32 s67, s59, 12
    s_add_u32 s65, s65, s67
    s_add_u32 s65, s65, 16384
    s_lshl_b32 s66, s58, 10
    s_add_u32 s66, s66, 32768
    s_waitcnt lgkmcnt(0)
    s_mov_b32 s24, s4
    s_mov_b32 s25, s5
    s_mov_b32 s26, 1835008
    s_mov_b32 s27, 0x20000
    s_cmp_ge_u32 s58, 2
    s_cselect_b32 s32, s10, s8
    s_cselect_b32 s33, s11, s9
    s_mov_b32 s34, 401408
    s_mov_b32 s35, 0x20000
    s_mov_b32 s28, s12
    s_mov_b32 s29, s13
    s_mov_b32 s30, 1605632
    s_mov_b32 s31, 0x20000
    s_add_u32 s44, s18, 10485760
    s_addc_u32 s45, s19, 0
    s_mov_b32 s46, 131072
    s_mov_b32 s47, 0x20000
    s_load_dwordx2 s[56:57], s[44:45], 81920
    s_mov_b32 s36, s18
    s_mov_b32 s37, s19
    s_mov_b32 s38, 7602176
    s_mov_b32 s39, 0x20000
    s_add_u32 s40, s18, 8388608
    s_addc_u32 s41, s19, 0
    s_mov_b32 s42, 2097152
    s_mov_b32 s43, 0x20000
    s_cmp_ge_u32 s62, 14
    s_cbranch_scc1 LroleE
    s_movk_i32 s72, 0
    s_mov_b32 s73, 0
    s_add_u32 m0, s65, 0
    s_nop 0
    buffer_load_dwordx4 v8, s[28:31], s73 offen offset:0 lds
    buffer_load_dwordx4 v9, s[28:31], s73 offen offset:1024 lds
    buffer_load_dwordx4 v10, s[28:31], s73 offen offset:2048 lds
    buffer_load_dwordx4 v11, s[28:31], s73 offen offset:3072 lds
    s_movk_i32 s72, 128
    s_mov_b32 s73, 229376
    s_add_u32 m0, s65, 36864
    s_nop 0
    buffer_load_dwordx4 v8, s[28:31], s73 offen offset:0 lds
    buffer_load_dwordx4 v9, s[28:31], s73 offen offset:1024 lds
    buffer_load_dwordx4 v10, s[28:31], s73 offen offset:2048 lds
    buffer_load_dwordx4 v11, s[28:31], s73 offen offset:3072 lds
    s_movk_i32 s72, 256
    s_mov_b32 s73, 458752
    s_add_u32 m0, s65, 73728
    s_nop 0
    buffer_load_dwordx4 v8, s[28:31], s73 offen offset:0 lds
    buffer_load_dwordx4 v9, s[28:31], s73 offen offset:1024 lds
    buffer_load_dwordx4 v10, s[28:31], s73 offen offset:2048 lds
    buffer_load_dwordx4 v11, s[28:31], s73 offen offset:3072 lds
    v_and_b32 v2, 31, v1
    v_lshrrev_b32 v3, 5, v1
    v_bfe_u32 v104, v2, 1, 3
    v_xor_b32 v104, v104, v3
    v_lshlrev_b32 v105, 7, v2
    s_xor_b32 s67, s58, 1
    s_lshl_b32 s67, s67, 12
    v_xor_b32 v106, 0, v104
    v_lshl_add_u32 v106, v106, 4, v105
    v_add_u32 v13, s64, v106
    v_add_u32 v21, s67, v106
    v_add_u32 v29, 0x8000, v106
    v_add_u32 v17, 73728, v13
    v_add_u32 v25, 73728, v21
    v_add_u32 v33, 73728, v29
    v_xor_b32 v106, 2, v104
    v_lshl_add_u32 v106, v106, 4, v105
    v_add_u32 v14, s64, v106
    v_add_u32 v22, s67, v106
    v_add_u32 v30, 0x8000, v106
    v_add_u32 v18, 73728, v14
    v_add_u32 v26, 73728, v22
    v_add_u32 v34, 73728, v30
    v_xor_b32 v106, 4, v104
    v_lshl_add_u32 v106, v106, 4, v105
    v_add_u32 v15, s64, v106
    v_add_u32 v23, s67, v106
    v_add_u32 v31, 0x8000, v106
    v_add_u32 v19, 73728, v15
    v_add_u32 v27, 73728, v23
    v_add_u32 v35, 73728, v31
    v_xor_b32 v106, 6, v104
    v_lshl_add_u32 v106, v106, 4, v105
    v_add_u32 v16, s64, v106
    v_add_u32 v24, s67, v106
    v_add_u32 v32, 0x8000, v106
    v_add_u32 v20, 73728, v16
    v_add_u32 v28, 73728, v24
    v_add_u32 v36, 73728, v32
    v_bfe_u32 v104, v1, 2, 2
    v_lshl_add_u32 v105, v3, 3, v104
    v_lshlrev_b32 v105, 7, v105
    v_lshrrev_b32 v104, 1, v104
    v_xor_b32 v104, s59, v104
    v_lshl_add_u32 v105, v104, 6, v105
    v_bfe_u32 v104, v1, 4, 1
    v_lshl_add_u32 v105, v104, 5, v105
    v_and_b32 v104, 3, v1
    v_lshl_add_u32 v105, v104, 3, v105
    s_lshl_b32 s67, s60, 13
    s_add_u32 s67, s67, 16384
    v_add_u32 v37, s67, v105
    v_xor_b32 v39, 64, v37
    v_add_u32 v38, 73728, v37
    v_add_u32 v40, 73728, v39
    v_lshlrev_b32 v42, 4, v2
    v_add_u32 v41, -1, v3
    s_lshl_b32 s79, s58, 7
    s_add_u32 s79, s79, 155648
    v_lshl_add_u32 v44, v2, 2, s79
    v_lshl_add_u32 v43, v3, 4, s79
    v_mov_b32 v72, 0x3f803f80
    v_mov_b32 v73, 0x3f803f80
    v_mov_b32 v74, 0x3f803f80
    v_mov_b32 v75, 0x3f803f80
    s_waitcnt lgkmcnt(0)
    s_add_u32 s56, s56, 0x7f4a7c15
    s_addc_u32 s57, s57, 0x9e3779b9
    s_waitcnt vmcnt(8)
    s_barrier
    ds_read_b64_tr_b16 v[104:105], v37 offset:0
    ds_read_b64_tr_b16 v[106:107], v37 offset:512
    ds_read_b64_tr_b16 v[112:113], v37 offset:2048
    ds_read_b64_tr_b16 v[114:115], v37 offset:2560
    ds_read_b64_tr_b16 v[120:121], v37 offset:4096
    ds_read_b64_tr_b16 v[122:123], v37 offset:4608
    ds_read_b64_tr_b16 v[128:129], v37 offset:6144
    ds_read_b64_tr_b16 v[130:131], v37 offset:6656
    s_movk_i32 s72, 384
    s_mov_b32 s73, 688128
    s_add_u32 m0, s65, 110592
    s_nop 0
    buffer_load_dwordx4 v8, s[28:31], s73 offen offset:0 lds
    buffer_load_dwordx4 v9, s[28:31], s73 offen offset:1024 lds
    buffer_load_dwordx4 v10, s[28:31], s73 offen offset:2048 lds
    buffer_load_dwordx4 v11, s[28:31], s73 offen offset:3072 lds
    s_waitcnt lgkmcnt(0)
    s_waitcnt vmcnt(8)
    s_barrier
    ds_read_b64_tr_b16 v[160:161], v37 offset:36864
    ds_read_b64_tr_b16 v[162:163], v37 offset:37376
    ds_read_b64_tr_b16 v[168:169], v37 offset:38912
    ds_read_b64_tr_b16 v[170:171], v37 offset:39424
    ds_read_b64_tr_b16 v[176:177], v37 offset:40960
    ds_read_b64_tr_b16 v[178:179], v37 offset:41472
    ds_read_b64_tr_b16 v[184:185], v37 offset:43008
    ds_read_b64_tr_b16 v[186:187], v37 offset:43520
    s_movk_i32 s72, 512
    s_mov_b32 s73, 917504
    s_add_u32 m0, s65, 0
    s_nop 0
    buffer_load_dwordx4 v8, s[28:31], s73 offen offset:0 lds
    buffer_load_dwordx4 v9, s[28:31], s73 offen offset:1024 lds
    buffer_load_dwordx4 v10, s[28:31], s73 offen offset:2048 lds
    buffer_load_dwordx4 v11, s[28:31], s73 offen offset:3072 lds
    v_mfma_f32_32x32x16_bf16 v[144:159], v[72:75], v[104:107], 0
    v_mfma_f32_32x32x16_bf16 v[144:159], v[72:75], v[112:115], v[144:159]
    v_mfma_f32_32x32x16_bf16 v[144:159], v[72:75], v[120:123], v[144:159]
    v_mfma_f32_32x32x16_bf16 v[144:159], v[72:75], v[128:131], v[144:159]
    s_waitcnt lgkmcnt(0)
    s_waitcnt vmcnt(8)
    s_barrier
    ds_read_b64_tr_b16 v[104:105], v38 offset:0
    ds_read_b64_tr_b16 v[106:107], v38 offset:512
    ds_read_b64_tr_b16 v[112:113], v38 offset:2048
    ds_read_b64_tr_b16 v[114:115], v38 offset:2560
    ds_read_b64_tr_b16 v[120:121], v38 offset:4096
    ds_read_b64_tr_b16 v[122:123], v38 offset:4608
    ds_read_b64_tr_b16 v[128:129], v38 offset:6144
    ds_read_b64_tr_b16 v[130:131], v38 offset:6656
    s_movk_i32 s72, 640
    s_mov_b32 s73, 1146880
    s_add_u32 m0, s65, 36864
    s_nop 0
    buffer_load_dwordx4 v8, s[28:31], s73 offen offset:0 lds
    buffer_load_dwordx4 v9, s[28:31], s73 offen offset:1024 lds
    buffer_load_dwordx4 v10, s[28:31], s73 offen offset:2048 lds
    buffer_load_dwordx4 v11, s[28:31], s73 offen offset:3072 lds
    v_mfma_f32_32x32x16_bf16 v[144:159], v[72:75], v[160:163], v[144:159]
    v_mfma_f32_32x32x16_bf16 v[144:159], v[72:75], v[168:171], v[144:159]
    v_mfma_f32_32x32x16_bf16 v[144:159], v[72:75], v[176:179], v[144:159]
    v_mfma_f32_32x32x16_bf16 v[144:159], v[72:75], v[184:187], v[144:159]
    s_waitcnt lgkmcnt(0)
    s_waitcnt vmcnt(8)
    s_barrier
    ds_read_b64_tr_b16 v[160:161], v38 offset:36864
    ds_read_b64_tr_b16 v[162:163], v38 offset:37376
    ds_read_b64_tr_b16 v[168:169], v38 offset:38912
    ds_read_b64_tr_b16 v[170:171], v38 offset:39424
    ds_read_b64_tr_b16 v[176:177], v38 offset:40960
    ds_read_b64_tr_b16 v[178:179], v38 offset:41472
    ds_read_b64_tr_b16 v[184:185], v38 offset:43008
    ds_read_b64_tr_b16 v[186:187], v38 offset:43520
    s_movk_i32 s72, 768
    s_mov_b32 s73, 1376256
    s_add_u32 m0, s65, 73728
    s_nop 0
    buffer_load_dwordx4 v8, s[28:31], s73 offen offset:0 lds
    buffer_load_dwordx4 v9, s[28:31], s73 offen offset:1024 lds
    buffer_load_dwordx4 v10, s[28:31], s73 offen offset:2048 lds
    buffer_load_dwordx4 v11, s[28:31], s73 offen offset:3072 lds
    v_mfma_f32_32x32x16_bf16 v[144:159], v[72:75], v[104:107], v[144:159]
    v_mfma_f32_32x32x16_bf16 v[144:159], v[72:75], v[112:115], v[144:159]
    v_mfma_f32_32x32x16_bf16 v[144:159], v[72:75], v[120:123], v[144:159]
    v_mfma_f32_32x32x16_bf16 v[144:159], v[72:75], v[128:131], v[144:159]
    s_waitcnt lgkmcnt(0)
    s_waitcnt vmcnt(8)
    s_barrier
    ds_read_b64_tr_b16 v[104:105], v37 offset:0
    ds_read_b64_tr_b16 v[106:107], v37 offset:512
    ds_read_b64_tr_b16 v[112:113], v37 offset:2048
    ds_read_b64_tr_b16 v[114:115], v37 offset:2560
    ds_read_b64_tr_b16 v[120:121], v37 offset:4096
    ds_read_b64_tr_b16 v[122:123], v37 offset:4608
    ds_read_b64_tr_b16 v[128:129], v37 offset:6144
    ds_read_b64_tr_b16 v[130:131], v37 offset:6656
    v_mfma_f32_32x32x16_bf16 v[144:159], v[72:75], v[160:163], v[144:159]
    v_mfma_f32_32x32x16_bf16 v[144:159], v[72:75], v[168:171], v[144:159]
    v_mfma_f32_32x32x16_bf16 v[144:159], v[72:75], v[176:179], v[144:159]
    v_mfma_f32_32x32x16_bf16 v[144:159], v[72:75], v[184:187], v[144:159]
    s_waitcnt lgkmcnt(0)
    s_waitcnt vmcnt(4)
    s_barrier
    ds_read_b64_tr_b16 v[160:161], v37 offset:36864
    ds_read_b64_tr_b16 v[162:163], v37 offset:37376
    ds_read_b64_tr_b16 v[168:169], v37 offset:38912
    ds_read_b64_tr_b16 v[170:171], v37 offset:39424
    ds_read_b64_tr_b16 v[176:177], v37 offset:40960
    ds_read_b64_tr_b16 v[178:179], v37 offset:41472
    ds_read_b64_tr_b16 v[184:185], v37 offset:43008
    ds_read_b64_tr_b16 v[186:187], v37 offset:43520
    v_mfma_f32_32x32x16_bf16 v[144:159], v[72:75], v[104:107], v[144:159]
    v_mfma_f32_32x32x16_bf16 v[144:159], v[72:75], v[112:115], v[144:159]
    v_mfma_f32_32x32x16_bf16 v[144:159], v[72:75], v[120:123], v[144:159]
    v_mfma_f32_32x32x16_bf16 v[144:159], v[72:75], v[128:131], v[144:159]
    s_waitcnt lgkmcnt(0)
    s_waitcnt vmcnt(0)
    s_barrier
    ds_read_b64_tr_b16 v[104:105], v38 offset:0
    ds_read_b64_tr_b16 v[106:107], v38 offset:512
    ds_read_b64_tr_b16 v[112:113], v38 offset:2048
    ds_read_b64_tr_b16 v[114:115], v38 offset:2560
    ds_read_b64_tr_b16 v[120:121], v38 offset:4096
    ds_read_b64_tr_b16 v[122:123], v38 offset:4608
    ds_read_b64_tr_b16 v[128:129], v38 offset:6144
    ds_read_b64_tr_b16 v[130:131], v38 offset:6656
    v_mfma_f32_32x32x16_bf16 v[144:159], v[72:75], v[160:163], v[144:159]
    v_mfma_f32_32x32x16_bf16 v[144:159], v[72:75], v[168:171], v[144:159]
    v_mfma_f32_32x32x16_bf16 v[144:159], v[72:75], v[176:179], v[144:159]
    v_mfma_f32_32x32x16_bf16 v[144:159], v[72:75], v[184:187], v[144:159]
    s_waitcnt lgkmcnt(0)
    v_mfma_f32_32x32x16_bf16 v[144:159], v[72:75], v[104:107], v[144:159]
    v_mfma_f32_32x32x16_bf16 v[144:159], v[72:75], v[112:115], v[144:159]
    v_mfma_f32_32x32x16_bf16 v[144:159], v[72:75], v[120:123], v[144:159]
    v_mfma_f32_32x32x16_bf16 v[144:159], v[72:75], v[128:131], v[144:159]
    s_nop 11
    v_cvt_pk_bf16_f32 v106, v144, v144
    v_and_b32 v107, 0xffff0000, v106
    v_sub_f32 v108, v144, v107
    v_cvt_pk_bf16_f32 v104, v144, v108
    v_and_b32 v107, 0xffff0000, v104
    v_sub_f32 v108, v108, v107
    v_cvt_pk_bf16_f32 v105, v108, 0
    v_mov_b32 v106, s56
    v_mov_b32 v107, s57
    s_lshl_b32 s74, s62, 11
    s_lshl_b32 s75, s60, 10
    s_add_u32 s74, s74, s75
    s_lshl_b32 s75, s59, 9
    s_add_u32 s74, s74, s75
    s_add_u32 s74, s74, 32768
    buffer_store_dwordx4 v[104:107], v42, s[44:47], s74 offen sc1
    s_mov_b32 s62, 15
    s_lshl_b32 s79, s62, 4
    s_add_u32 s79, s79, s61
    s_lshl_b32 s79, s79, 3
    s_add_u32 s79, s79, 69632
    s_lshl_b32 s80, s61, 4
    s_add_u32 s80, s80, s62
    s_lshl_b32 s80, s80, 3
    s_add_u32 s80, s80, 65536
    s_sub_u32 s80, s80, s79
    v_mul_lo_u32 v94, v1, s80
    v_add_u32 v94, s79, v94
    v_mov_b32 v92, s56
    v_mov_b32 v93, s57
    s_barrier
    s_cmp_lg_u32 s58, 0
    s_cbranch_scc1 Lnofl_9
    s_mov_b64 exec, 3
    buffer_store_dwordx2 v[92:93], v94, s[44:47], 0 offen sc1
    s_mov_b64 exec, -1
Lnofl_9:
    s_branch Lfin
LroleE:
    s_waitcnt lgkmcnt(0)
    s_add_u32 s56, s56, 0x7f4a7c15
    s_addc_u32 s57, s57, 0x9e3779b9
    s_sub_u32 s69, 15, s62
    s_add_u32 s69, s69, s58
    s_mov_b32 s62, 15
    s_lshl_b32 s79, s62, 4
    s_add_u32 s79, s79, s61
    s_lshl_b32 s79, s79, 3
    s_add_u32 s79, s79, 69632
    s_lshl_b32 s80, s61, 4
    s_add_u32 s80, s80, s62
    s_lshl_b32 s80, s80, 3
    s_add_u32 s80, s80, 65536
    s_sub_u32 s80, s80, s79
    v_mul_lo_u32 v94, v1, s80
    v_add_u32 v94, s79, v94
    v_mov_b32 v92, s56
    v_mov_b32 v93, s57
    s_barrier
    s_cmp_lg_u32 s58, 0
    s_cbranch_scc1 Lnofl_10
    s_mov_b64 exec, 3
    buffer_store_dwordx2 v[92:93], v94, s[44:47], 0 offen sc1
    s_mov_b64 exec, -1
Lnofl_10:
    s_cmp_lg_u32 s69, 0
    s_cbranch_scc1 Lfin
    v_lshlrev_b32 v55, 3, v1
    v_add_u32 v55, 69632, v55
    buffer_load_dwordx2 v[46:47], v55, s[44:47], 0 offen sc1
    s_waitcnt vmcnt(0)
    v_cmp_ne_u64 vcc, s[56:57], v[46:47]
    s_cbranch_vccz Lok_11
    s_mov_b32 s78, 131072
Lspin_12:
    s_sleep 16
    buffer_load_dwordx2 v[46:47], v55, s[44:47], 0 offen sc1
    s_sub_u32 s78, s78, 1
    s_cbranch_scc1 Lok_11
    s_waitcnt vmcnt(0)
    v_cmp_ne_u64 vcc, s[56:57], v[46:47]
    s_cbranch_vccnz Lspin_12
Lok_11:
    v_add_u32 v55, 512, v55
    buffer_load_dwordx2 v[46:47], v55, s[44:47], 0 offen sc1
    s_waitcnt vmcnt(0)
    v_cmp_ne_u64 vcc, s[56:57], v[46:47]
    s_cbranch_vccz Lok_13
    s_mov_b32 s78, 131072
Lspin_14:
    s_sleep 16
    buffer_load_dwordx2 v[46:47], v55, s[44:47], 0 offen sc1
    s_sub_u32 s78, s78, 1
    s_cbranch_scc1 Lok_13
    s_waitcnt vmcnt(0)
    v_cmp_ne_u64 vcc, s[56:57], v[46:47]
    s_cbranch_vccnz Lspin_14
Lok_13:
    v_add_u32 v55, 512, v55
    buffer_load_dwordx2 v[46:47], v55, s[44:47], 0 offen sc1
    s_waitcnt vmcnt(0)
    v_cmp_ne_u64 vcc, s[56:57], v[46:47]
    s_cbranch_vccz Lok_15
    s_mov_b32 s78, 131072
Lspin_16:
    s_sleep 16
    buffer_load_dwordx2 v[46:47], v55, s[44:47], 0 offen sc1
    s_sub_u32 s78, s78, 1
    s_cbranch_scc1 Lok_15
    s_waitcnt vmcnt(0)
    v_cmp_ne_u64 vcc, s[56:57], v[46:47]
    s_cbranch_vccnz Lspin_16
Lok_15:
    v_add_u32 v55, 512, v55
    buffer_load_dwordx2 v[46:47], v55, s[44:47], 0 offen sc1
    s_waitcnt vmcnt(0)
    v_cmp_ne_u64 vcc, s[56:57], v[46:47]
    s_cbranch_vccz Lok_17
    s_mov_b32 s78, 131072
Lspin_18:
    s_sleep 16
    buffer_load_dwordx2 v[46:47], v55, s[44:47], 0 offen sc1
    s_sub_u32 s78, s78, 1
    s_cbranch_scc1 Lok_17
    s_waitcnt vmcnt(0)
    v_cmp_ne_u64 vcc, s[56:57], v[46:47]
    s_cbranch_vccnz Lspin_18
Lok_17:
    v_add_u32 v55, 512, v55
    v_mov_b32 v94, 81920
    s_mov_b64 exec, 1
    buffer_store_dwordx2 v[92:93], v94, s[44:47], 0 offen sc1
    s_mov_b64 exec, -1
Lfin:
Lend:
    s_endpgm
.section .rodata,"a"
.p2align 6
.amdhsa_kernel parallel_sum__spectral_fnet__dense_activation_relu__prompt_kernel
  .amdhsa_next_free_vgpr 512
  .amdhsa_next_free_sgpr 102
  .amdhsa_accum_offset 256
  .amdhsa_group_segment_fixed_size 0
  .amdhsa_kernarg_size 88
  .amdhsa_user_sgpr_count 2
  .amdhsa_user_sgpr_kernarg_segment_ptr 1
  .amdhsa_system_sgpr_workgroup_id_x 1
.end_amdhsa_kernel
```
